```python
import torch

def _softmax(x, axis=-1):
    return torch.softmax(x, dim=axis)
def _gelu(x):
    return torch.nn.functional.gelu(x, approximate="tanh")
def _silu(x):
    return torch.nn.functional.silu(x)
def _sigmoid(x):
    return torch.sigmoid(x)
def _layernorm(x, axis=-1, eps=1e-5):
    m = x.mean(dim=axis, keepdim=True)
    v = x.var(dim=axis, keepdim=True, unbiased=False)
    return (x - m) / torch.sqrt(v + eps)
def _scatter_add(tgt, idx, src, axis=0):
    return tgt.clone().index_add_(axis, idx, src)
def _segment_sum(src, seg, n):
    out = torch.zeros((n,) + src.shape[1:], dtype=src.dtype)
    return out.index_add_(0, seg, src)
def _pad(x, pw):
    flat = tuple(v for pair in reversed(pw) for v in pair)
    return torch.nn.functional.pad(x, flat)

kernel_name = 'gated_mix__mha_block_cached__glu_gated_geglu__decode'

def setup_inputs():

    _w = (lambda a: (lambda t: t.to(torch.bfloat16) if t.is_floating_point() else t)(torch.as_tensor(a)))
    def _A_setup():
        B, Sq, D = 4, 1, 640
        H, Sk, Dh = 32, 8192, 192
        return {
            "x": _w((lambda *s: torch.randn(*s, dtype=torch.bfloat16) * 0.05)(B, Sq, D)),
            "k_cache": _w((lambda *s: torch.randn(*s, dtype=torch.bfloat16) * 3.2)(B, H, Sk, Dh)),
            "v_cache": _w((lambda *s: torch.randn(*s, dtype=torch.bfloat16) * 0.05)(B, H, Sk, Dh)),
            "wq": _w((lambda *s: torch.randn(*s, dtype=torch.bfloat16) * 3.2)(D, H * Dh) * (D ** -0.5)),
            "wo": _w((lambda *s: torch.randn(*s, dtype=torch.bfloat16) * 0.05)(H * Dh, D) * ((H * Dh) ** -0.5)),
        }
    _A_in = _A_setup()

    def _B_setup():
        B, S, Dm, Df = 4, 1, 640, 1536
        return {
            "x": _w((lambda *s: torch.randn(*s, dtype=torch.bfloat16) * 0.05)(B, S, Dm)),
            "w_gate": _w((lambda *s: torch.randn(*s, dtype=torch.bfloat16) * 0.2)(Dm, Df) * (Dm ** -0.5)),
            "w_up": _w((lambda *s: torch.randn(*s, dtype=torch.bfloat16) * 0.2)(Dm, Df) * (Dm ** -0.5)),
            "w_down": _w((lambda *s: torch.randn(*s, dtype=torch.bfloat16) * 0.2)(Df, Dm) * (Df ** -0.5)),
        }
    _B_in = _B_setup()

    return {
        "A_x": _A_in["x"],
        "A_k_cache": _A_in["k_cache"],
        "A_v_cache": _A_in["v_cache"],
        "A_wq": _A_in["wq"],
        "A_wo": _A_in["wo"],
        "B_x": _B_in["x"],
        "B_w_gate": _B_in["w_gate"],
        "B_w_up": _B_in["w_up"],
        "B_w_down": _B_in["w_down"],
        "gate_w": _w((lambda *s: torch.randn(*s, dtype=torch.bfloat16) * 0.05)(640) * 16.0),
    }

def reference(A_x, A_k_cache, A_v_cache, A_wq, A_wo, B_x, B_w_gate, B_w_up, B_w_down, gate_w):
    def _A_ref(x, k_cache, v_cache, wq, wo):
        B, Sq, D = x.shape
        H, Dh = 32, 192
        q = (lambda x, *d: x.permute(*d))((x @ wq).reshape(B, Sq, H, Dh), 0, 2, 1, 3)
        scores = torch.einsum("bhqd,bhkd->bhqk", q, k_cache) * (Dh ** -0.5)
        p = _softmax(scores, axis=-1)
        o = torch.einsum("bhqk,bhkd->bhqd", p, v_cache)
        return (lambda x, *d: x.permute(*d))(o, 0, 2, 1, 3).reshape(B, Sq, H * Dh) @ wo

    def _B_ref(x, w_gate, w_up, w_down):
        g = torch.einsum("bsd,df->bsf", x, w_gate)
        u = torch.einsum("bsd,df->bsf", x, w_up)
        h = _gelu(g) * u
        return torch.einsum("bsf,fd->bsd", h, w_down)

    x = A_x
    g = _sigmoid((x * gate_w).sum(-1, keepdims=True))
    a = _A_ref(x, A_k_cache, A_v_cache, A_wq, A_wo)
    b = _B_ref(x, B_w_gate, B_w_up, B_w_down)
    return g * a + (1 - g) * b
```

```asm
; @launch kernel=pre_kernel grid=(145,1,1) block=(512,1,1) lds=8192
; @launch kernel=main_kernel grid=(256,1,1) block=(576,1,1) lds=30464
.amdgcn_target "amdgcn-amd-amdhsa--gfx950"
.text
.macro SLABMAC acc, w, xlo, xhi
    v_lshlrev_b32 v[\xhi], 16, v[\xlo]
    v_dot2c_f32_bf16_dpp v[\acc+0], v[\xlo], v[\w+0] quad_perm:[0,0,0,0] row_mask:0xf bank_mask:0xf
    v_dot2c_f32_bf16_dpp v[\acc+2], v[\xlo], v[\w+1] quad_perm:[0,0,0,0] row_mask:0xf bank_mask:0xf
    v_dot2c_f32_bf16_dpp v[\acc+4], v[\xlo], v[\w+2] quad_perm:[0,0,0,0] row_mask:0xf bank_mask:0xf
    v_dot2c_f32_bf16_dpp v[\acc+6], v[\xlo], v[\w+3] quad_perm:[0,0,0,0] row_mask:0xf bank_mask:0xf
    v_dot2c_f32_bf16_dpp v[\acc+8], v[\xlo], v[\w+0] quad_perm:[1,1,1,1] row_mask:0xf bank_mask:0xf
    v_dot2c_f32_bf16_dpp v[\acc+10], v[\xlo], v[\w+1] quad_perm:[1,1,1,1] row_mask:0xf bank_mask:0xf
    v_dot2c_f32_bf16_dpp v[\acc+12], v[\xlo], v[\w+2] quad_perm:[1,1,1,1] row_mask:0xf bank_mask:0xf
    v_dot2c_f32_bf16_dpp v[\acc+14], v[\xlo], v[\w+3] quad_perm:[1,1,1,1] row_mask:0xf bank_mask:0xf
    v_dot2c_f32_bf16_dpp v[\acc+16], v[\xlo], v[\w+0] quad_perm:[2,2,2,2] row_mask:0xf bank_mask:0xf
    v_dot2c_f32_bf16_dpp v[\acc+18], v[\xlo], v[\w+1] quad_perm:[2,2,2,2] row_mask:0xf bank_mask:0xf
    v_dot2c_f32_bf16_dpp v[\acc+20], v[\xlo], v[\w+2] quad_perm:[2,2,2,2] row_mask:0xf bank_mask:0xf
    v_dot2c_f32_bf16_dpp v[\acc+22], v[\xlo], v[\w+3] quad_perm:[2,2,2,2] row_mask:0xf bank_mask:0xf
    v_dot2c_f32_bf16_dpp v[\acc+24], v[\xlo], v[\w+0] quad_perm:[3,3,3,3] row_mask:0xf bank_mask:0xf
    v_dot2c_f32_bf16_dpp v[\acc+26], v[\xlo], v[\w+1] quad_perm:[3,3,3,3] row_mask:0xf bank_mask:0xf
    v_dot2c_f32_bf16_dpp v[\acc+28], v[\xlo], v[\w+2] quad_perm:[3,3,3,3] row_mask:0xf bank_mask:0xf
    v_dot2c_f32_bf16_dpp v[\acc+30], v[\xlo], v[\w+3] quad_perm:[3,3,3,3] row_mask:0xf bank_mask:0xf
    v_dot2c_f32_bf16_dpp v[\acc+1], v[\xhi], v[\w+0] quad_perm:[0,0,0,0] row_mask:0xf bank_mask:0xf
    v_dot2c_f32_bf16_dpp v[\acc+3], v[\xhi], v[\w+1] quad_perm:[0,0,0,0] row_mask:0xf bank_mask:0xf
    v_dot2c_f32_bf16_dpp v[\acc+5], v[\xhi], v[\w+2] quad_perm:[0,0,0,0] row_mask:0xf bank_mask:0xf
    v_dot2c_f32_bf16_dpp v[\acc+7], v[\xhi], v[\w+3] quad_perm:[0,0,0,0] row_mask:0xf bank_mask:0xf
    v_dot2c_f32_bf16_dpp v[\acc+9], v[\xhi], v[\w+0] quad_perm:[1,1,1,1] row_mask:0xf bank_mask:0xf
    v_dot2c_f32_bf16_dpp v[\acc+11], v[\xhi], v[\w+1] quad_perm:[1,1,1,1] row_mask:0xf bank_mask:0xf
    v_dot2c_f32_bf16_dpp v[\acc+13], v[\xhi], v[\w+2] quad_perm:[1,1,1,1] row_mask:0xf bank_mask:0xf
    v_dot2c_f32_bf16_dpp v[\acc+15], v[\xhi], v[\w+3] quad_perm:[1,1,1,1] row_mask:0xf bank_mask:0xf
    v_dot2c_f32_bf16_dpp v[\acc+17], v[\xhi], v[\w+0] quad_perm:[2,2,2,2] row_mask:0xf bank_mask:0xf
    v_dot2c_f32_bf16_dpp v[\acc+19], v[\xhi], v[\w+1] quad_perm:[2,2,2,2] row_mask:0xf bank_mask:0xf
    v_dot2c_f32_bf16_dpp v[\acc+21], v[\xhi], v[\w+2] quad_perm:[2,2,2,2] row_mask:0xf bank_mask:0xf
    v_dot2c_f32_bf16_dpp v[\acc+23], v[\xhi], v[\w+3] quad_perm:[2,2,2,2] row_mask:0xf bank_mask:0xf
    v_dot2c_f32_bf16_dpp v[\acc+25], v[\xhi], v[\w+0] quad_perm:[3,3,3,3] row_mask:0xf bank_mask:0xf
    v_dot2c_f32_bf16_dpp v[\acc+27], v[\xhi], v[\w+1] quad_perm:[3,3,3,3] row_mask:0xf bank_mask:0xf
    v_dot2c_f32_bf16_dpp v[\acc+29], v[\xhi], v[\w+2] quad_perm:[3,3,3,3] row_mask:0xf bank_mask:0xf
    v_dot2c_f32_bf16_dpp v[\acc+31], v[\xhi], v[\w+3] quad_perm:[3,3,3,3] row_mask:0xf bank_mask:0xf
.endm
.globl pre_kernel
.p2align 8
.type pre_kernel,@function
pre_kernel:
    s_cmp_ge_u32 s2, 145
    s_cbranch_scc1 LP_end
    s_load_dwordx2 s[4:5], s[0:1], 0
    s_load_dwordx2 s[10:11], s[0:1], 24
    s_load_dwordx4 s[64:67], s[0:1], 48
    s_load_dwordx2 s[70:71], s[0:1], 72
    s_load_dwordx2 s[16:17], s[0:1], 96
    v_and_b32 v1, 63, v0
    v_and_b32 v2, 7, v0
    v_bfe_u32 v3, v0, 3, 3
    v_lshrrev_b32 v8, 6, v0
    s_nop 0
    v_readfirstlane_b32 s18, v8
    v_bfe_u32 v8, v1, 5, 1
    v_bfe_u32 v9, v1, 4, 1
    v_lshl_add_u32 v8, v9, 1, v8
    v_lshl_add_u32 v11, v2, 3, v8
    s_waitcnt lgkmcnt(0)
    s_mov_b32 s32, s4
    s_mov_b32 s33, s5
    s_mov_b32 s34, 5120
    s_mov_b32 s35, 0x20000
    s_mov_b32 s52, s16
    s_mov_b32 s53, s17
    s_mov_b32 s54, 1900544
    s_mov_b32 s55, 0x20000
    s_cmp_eq_u32 s2, 144
    s_cbranch_scc1 LP_gate
    s_cmp_ge_u32 s2, 96
    s_cbranch_scc1 LP_ffn
    s_lshl_b32 s21, s2, 7
    s_add_u32 s24, s10, s21
    s_addc_u32 s25, s11, 0
    s_sub_u32 s26, 7864320, s21
    s_movk_i32 s28, 12288
    s_branch LP_go
LP_ffn:
    s_cmp_ge_u32 s2, 120
    s_cselect_b32 s24, s66, s64
    s_cselect_b32 s25, s67, s65
    s_movk_i32 s21, 96
    s_cselect_b32 s21, 120, s21
    s_sub_u32 s21, s2, s21
    s_lshl_b32 s21, s21, 7
    s_add_u32 s24, s24, s21
    s_addc_u32 s25, s25, 0
    s_sub_u32 s26, 1966080, s21
    s_movk_i32 s28, 3072
LP_go:
    s_mov_b32 s27, 0x20000
    s_mul_i32 s22, s18, 80
    v_add_u32 v8, s22, v3
    v_and_b32 v10, 3, v2
    v_mul_u32_u24 v10, 1280, v10
    v_lshl_add_u32 v10, v8, 1, v10
    buffer_load_ushort v12, v10, s[32:35], 0 offen offset:0
    buffer_load_ushort v13, v10, s[32:35], 0 offen offset:16
    buffer_load_ushort v14, v10, s[32:35], 0 offen offset:32
    buffer_load_ushort v15, v10, s[32:35], 0 offen offset:48
    buffer_load_ushort v16, v10, s[32:35], 0 offen offset:64
    buffer_load_ushort v17, v10, s[32:35], 0 offen offset:80
    buffer_load_ushort v18, v10, s[32:35], 0 offen offset:96
    buffer_load_ushort v19, v10, s[32:35], 0 offen offset:112
    buffer_load_ushort v20, v10, s[32:35], 0 offen offset:128
    buffer_load_ushort v21, v10, s[32:35], 0 offen offset:144
    v_mul_lo_u32 v10, v8, s28
    v_lshl_add_u32 v10, v2, 4, v10
    s_lshl_b32 s23, s28, 3
    s_mul_i32 s22, s23, 0
    buffer_load_dwordx4 v[64:67], v10, s[24:27], s22 offen
    s_mul_i32 s22, s23, 1
    buffer_load_dwordx4 v[68:71], v10, s[24:27], s22 offen
    s_mul_i32 s22, s23, 2
    buffer_load_dwordx4 v[72:75], v10, s[24:27], s22 offen
    s_mul_i32 s22, s23, 3
    buffer_load_dwordx4 v[76:79], v10, s[24:27], s22 offen
    s_mul_i32 s22, s23, 4
    buffer_load_dwordx4 v[80:83], v10, s[24:27], s22 offen
    s_mul_i32 s22, s23, 5
    buffer_load_dwordx4 v[84:87], v10, s[24:27], s22 offen
    s_mul_i32 s22, s23, 6
    buffer_load_dwordx4 v[88:91], v10, s[24:27], s22 offen
    s_mul_i32 s22, s23, 7
    buffer_load_dwordx4 v[92:95], v10, s[24:27], s22 offen
    s_mul_i32 s22, s23, 8
    buffer_load_dwordx4 v[96:99], v10, s[24:27], s22 offen
    s_mul_i32 s22, s23, 9
    buffer_load_dwordx4 v[100:103], v10, s[24:27], s22 offen
    s_mov_b32 s40, s16
    s_mov_b32 s41, s17
    s_mov_b32 s42, 1368064
    s_mov_b32 s43, 0x20000
    v_mov_b32 v24, -1
    v_mov_b32 v25, -1
    v_mov_b32 v26, -1
    v_mov_b32 v27, -1
    s_lshl_b32 s44, s2, 13
    v_lshlrev_b32 v9, 4, v0
    buffer_store_dwordx4 v[24:27], v9, s[40:43], s44 offen
    s_add_u32 s44, s44, 1179648
    buffer_store_dwordx4 v[24:27], v9, s[40:43], s44 offen
    v_mov_b32 v32, 0
    v_mov_b32 v33, 0
    v_mov_b32 v34, 0
    v_mov_b32 v35, 0
    v_mov_b32 v36, 0
    v_mov_b32 v37, 0
    v_mov_b32 v38, 0
    v_mov_b32 v39, 0
    v_mov_b32 v40, 0
    v_mov_b32 v41, 0
    v_mov_b32 v42, 0
    v_mov_b32 v43, 0
    v_mov_b32 v44, 0
    v_mov_b32 v45, 0
    v_mov_b32 v46, 0
    v_mov_b32 v47, 0
    v_mov_b32 v48, 0
    v_mov_b32 v49, 0
    v_mov_b32 v50, 0
    v_mov_b32 v51, 0
    v_mov_b32 v52, 0
    v_mov_b32 v53, 0
    v_mov_b32 v54, 0
    v_mov_b32 v55, 0
    v_mov_b32 v56, 0
    v_mov_b32 v57, 0
    v_mov_b32 v58, 0
    v_mov_b32 v59, 0
    v_mov_b32 v60, 0
    v_mov_b32 v61, 0
    v_mov_b32 v62, 0
    v_mov_b32 v63, 0
    s_waitcnt vmcnt(11)
    SLABMAC 32, 64, 12, 30
    s_waitcnt vmcnt(10)
    SLABMAC 32, 68, 13, 30
    s_waitcnt vmcnt(9)
    SLABMAC 32, 72, 14, 30
    s_waitcnt vmcnt(8)
    SLABMAC 32, 76, 15, 30
    s_waitcnt vmcnt(7)
    SLABMAC 32, 80, 16, 30
    s_waitcnt vmcnt(6)
    SLABMAC 32, 84, 17, 30
    s_waitcnt vmcnt(5)
    SLABMAC 32, 88, 18, 30
    s_waitcnt vmcnt(4)
    SLABMAC 32, 92, 19, 30
    s_waitcnt vmcnt(3)
    SLABMAC 32, 96, 20, 30
    s_waitcnt vmcnt(2)
    SLABMAC 32, 100, 21, 30
    s_nop 2
    s_nop 1
    v_permlane32_swap_b32 v32, v33
    v_permlane32_swap_b32 v34, v35
    v_permlane32_swap_b32 v36, v37
    v_permlane32_swap_b32 v38, v39
    v_permlane32_swap_b32 v40, v41
    v_permlane32_swap_b32 v42, v43
    v_permlane32_swap_b32 v44, v45
    v_permlane32_swap_b32 v46, v47
    v_permlane32_swap_b32 v48, v49
    v_permlane32_swap_b32 v50, v51
    v_permlane32_swap_b32 v52, v53
    v_permlane32_swap_b32 v54, v55
    v_permlane32_swap_b32 v56, v57
    v_permlane32_swap_b32 v58, v59
    v_permlane32_swap_b32 v60, v61
    v_permlane32_swap_b32 v62, v63
    s_nop 0
    v_add_f32 v32, v32, v33
    v_add_f32 v34, v34, v35
    v_add_f32 v36, v36, v37
    v_add_f32 v38, v38, v39
    v_add_f32 v40, v40, v41
    v_add_f32 v42, v42, v43
    v_add_f32 v44, v44, v45
    v_add_f32 v46, v46, v47
    v_add_f32 v48, v48, v49
    v_add_f32 v50, v50, v51
    v_add_f32 v52, v52, v53
    v_add_f32 v54, v54, v55
    v_add_f32 v56, v56, v57
    v_add_f32 v58, v58, v59
    v_add_f32 v60, v60, v61
    v_add_f32 v62, v62, v63
    s_nop 0
    v_permlane16_swap_b32 v32, v34
    v_permlane16_swap_b32 v36, v38
    v_permlane16_swap_b32 v40, v42
    v_permlane16_swap_b32 v44, v46
    v_permlane16_swap_b32 v48, v50
    v_permlane16_swap_b32 v52, v54
    v_permlane16_swap_b32 v56, v58
    v_permlane16_swap_b32 v60, v62
    s_nop 0
    v_add_f32 v32, v32, v34
    v_add_f32 v36, v36, v38
    v_add_f32 v40, v40, v42
    v_add_f32 v44, v44, v46
    v_add_f32 v48, v48, v50
    v_add_f32 v52, v52, v54
    v_add_f32 v56, v56, v58
    v_add_f32 v60, v60, v62
    s_nop 0
    v_add_f32_dpp v32, v32, v32 row_ror:8 row_mask:0xf bank_mask:0xf
    v_add_f32_dpp v36, v36, v36 row_ror:8 row_mask:0xf bank_mask:0xf
    v_add_f32_dpp v40, v40, v40 row_ror:8 row_mask:0xf bank_mask:0xf
    v_add_f32_dpp v44, v44, v44 row_ror:8 row_mask:0xf bank_mask:0xf
    v_add_f32_dpp v48, v48, v48 row_ror:8 row_mask:0xf bank_mask:0xf
    v_add_f32_dpp v52, v52, v52 row_ror:8 row_mask:0xf bank_mask:0xf
    v_add_f32_dpp v56, v56, v56 row_ror:8 row_mask:0xf bank_mask:0xf
    v_add_f32_dpp v60, v60, v60 row_ror:8 row_mask:0xf bank_mask:0xf
    v_lshlrev_b32 v8, 2, v11
    s_lshl_b32 s21, s18, 10
    v_add_u32 v8, s21, v8
    ds_write_b32 v8, v32 offset:0
    ds_write_b32 v8, v36 offset:16
    ds_write_b32 v8, v40 offset:256
    ds_write_b32 v8, v44 offset:272
    ds_write_b32 v8, v48 offset:512
    ds_write_b32 v8, v52 offset:528
    ds_write_b32 v8, v56 offset:768
    ds_write_b32 v8, v60 offset:784
    s_waitcnt lgkmcnt(0)
    s_barrier
    s_cmp_ge_u32 s18, 4
    s_cbranch_scc1 LP_end
    v_lshlrev_b32 v8, 2, v0
    ds_read_b32 v32, v8 offset:0
    ds_read_b32 v33, v8 offset:1024
    ds_read_b32 v34, v8 offset:2048
    ds_read_b32 v35, v8 offset:3072
    ds_read_b32 v36, v8 offset:4096
    ds_read_b32 v37, v8 offset:5120
    ds_read_b32 v38, v8 offset:6144
    ds_read_b32 v39, v8 offset:7168
    s_waitcnt lgkmcnt(0)
    v_add_f32 v32, v32, v33
    v_add_f32 v32, v32, v34
    v_add_f32 v32, v32, v35
    v_add_f32 v32, v32, v36
    v_add_f32 v32, v32, v37
    v_add_f32 v32, v32, v38
    v_add_f32 v32, v32, v39
    s_cmp_ge_u32 s2, 96
    s_cbranch_scc1 LP_ffn_out
    v_cvt_pk_bf16_f32 v32, v32, v32
    s_mul_i32 s21, s18, 12288
    s_lshl_b32 s22, s2, 7
    s_add_u32 s21, s21, s22
    s_add_u32 s21, s21, 1376256
    v_lshlrev_b32 v8, 1, v1
    buffer_store_short v32, v8, s[52:55], s21 offen
    s_endpgm
LP_ffn_out:
    s_cmp_ge_u32 s2, 120
    s_movk_i32 s21, 96
    s_cselect_b32 s21, 120, s21
    s_cselect_b32 s23, 24576, 0
    s_sub_u32 s21, s2, s21
    s_lshl_b32 s21, s21, 8
    s_add_u32 s21, s21, s23
    s_mul_i32 s22, s18, 6144
    s_add_u32 s21, s21, s22
    s_add_u32 s21, s21, 1441792
    v_lshlrev_b32 v8, 2, v1
    buffer_store_dword v32, v8, s[52:55], s21 offen
    s_endpgm
LP_gate:
    s_cmp_lg_u32 s18, 0
    s_cbranch_scc1 LP_end
    s_mov_b32 s36, s70
    s_mov_b32 s37, s71
    s_mov_b32 s38, 1280
    s_mov_b32 s39, 0x20000
    v_and_b32 v8, 15, v1
    v_lshlrev_b32 v8, 4, v8
    v_lshrrev_b32 v9, 4, v1
    v_mul_u32_u24 v9, 1280, v9
    v_add_u32 v9, v9, v8
    buffer_load_dwordx4 v[32:35], v9, s[32:35], 0 offen offset:0
    buffer_load_dwordx4 v[64:67], v8, s[36:39], 0 offen offset:0
    buffer_load_dwordx4 v[36:39], v9, s[32:35], 0 offen offset:256
    buffer_load_dwordx4 v[68:71], v8, s[36:39], 0 offen offset:256
    buffer_load_dwordx4 v[40:43], v9, s[32:35], 0 offen offset:512
    buffer_load_dwordx4 v[72:75], v8, s[36:39], 0 offen offset:512
    buffer_load_dwordx4 v[44:47], v9, s[32:35], 0 offen offset:768
    buffer_load_dwordx4 v[76:79], v8, s[36:39], 0 offen offset:768
    buffer_load_dwordx4 v[48:51], v9, s[32:35], 0 offen offset:1024
    buffer_load_dwordx4 v[80:83], v8, s[36:39], 0 offen offset:1024
    v_lshlrev_b32 v10, 8, v1
    v_mov_b32 v12, 0
    s_mov_b64 exec, 0xffffffff
    s_mov_b32 s21, 1572864
    buffer_store_dword v12, v10, s[52:55], s21 offen
    s_mov_b64 exec, -1
    s_waitcnt vmcnt(0)
    v_mov_b32 v12, 0
    v_lshlrev_b32 v13, 16, v32
    v_lshlrev_b32 v14, 16, v64
    v_and_b32 v15, 0xffff0000, v32
    v_and_b32 v16, 0xffff0000, v64
    v_mul_f32 v13, v13, v14
    v_mul_f32 v15, v15, v16
    v_cvt_pk_bf16_f32 v13, v13, v15
    v_lshlrev_b32 v14, 16, v13
    v_and_b32 v15, 0xffff0000, v13
    v_add_f32 v12, v12, v14
    v_add_f32 v12, v12, v15
    v_lshlrev_b32 v13, 16, v33
    v_lshlrev_b32 v14, 16, v65
    v_and_b32 v15, 0xffff0000, v33
    v_and_b32 v16, 0xffff0000, v65
    v_mul_f32 v13, v13, v14
    v_mul_f32 v15, v15, v16
    v_cvt_pk_bf16_f32 v13, v13, v15
    v_lshlrev_b32 v14, 16, v13
    v_and_b32 v15, 0xffff0000, v13
    v_add_f32 v12, v12, v14
    v_add_f32 v12, v12, v15
    v_lshlrev_b32 v13, 16, v34
    v_lshlrev_b32 v14, 16, v66
    v_and_b32 v15, 0xffff0000, v34
    v_and_b32 v16, 0xffff0000, v66
    v_mul_f32 v13, v13, v14
    v_mul_f32 v15, v15, v16
    v_cvt_pk_bf16_f32 v13, v13, v15
    v_lshlrev_b32 v14, 16, v13
    v_and_b32 v15, 0xffff0000, v13
    v_add_f32 v12, v12, v14
    v_add_f32 v12, v12, v15
    v_lshlrev_b32 v13, 16, v35
    v_lshlrev_b32 v14, 16, v67
    v_and_b32 v15, 0xffff0000, v35
    v_and_b32 v16, 0xffff0000, v67
    v_mul_f32 v13, v13, v14
    v_mul_f32 v15, v15, v16
    v_cvt_pk_bf16_f32 v13, v13, v15
    v_lshlrev_b32 v14, 16, v13
    v_and_b32 v15, 0xffff0000, v13
    v_add_f32 v12, v12, v14
    v_add_f32 v12, v12, v15
    v_lshlrev_b32 v13, 16, v36
    v_lshlrev_b32 v14, 16, v68
    v_and_b32 v15, 0xffff0000, v36
    v_and_b32 v16, 0xffff0000, v68
    v_mul_f32 v13, v13, v14
    v_mul_f32 v15, v15, v16
    v_cvt_pk_bf16_f32 v13, v13, v15
    v_lshlrev_b32 v14, 16, v13
    v_and_b32 v15, 0xffff0000, v13
    v_add_f32 v12, v12, v14
    v_add_f32 v12, v12, v15
    v_lshlrev_b32 v13, 16, v37
    v_lshlrev_b32 v14, 16, v69
    v_and_b32 v15, 0xffff0000, v37
    v_and_b32 v16, 0xffff0000, v69
    v_mul_f32 v13, v13, v14
    v_mul_f32 v15, v15, v16
    v_cvt_pk_bf16_f32 v13, v13, v15
    v_lshlrev_b32 v14, 16, v13
    v_and_b32 v15, 0xffff0000, v13
    v_add_f32 v12, v12, v14
    v_add_f32 v12, v12, v15
    v_lshlrev_b32 v13, 16, v38
    v_lshlrev_b32 v14, 16, v70
    v_and_b32 v15, 0xffff0000, v38
    v_and_b32 v16, 0xffff0000, v70
    v_mul_f32 v13, v13, v14
    v_mul_f32 v15, v15, v16
    v_cvt_pk_bf16_f32 v13, v13, v15
    v_lshlrev_b32 v14, 16, v13
    v_and_b32 v15, 0xffff0000, v13
    v_add_f32 v12, v12, v14
    v_add_f32 v12, v12, v15
    v_lshlrev_b32 v13, 16, v39
    v_lshlrev_b32 v14, 16, v71
    v_and_b32 v15, 0xffff0000, v39
    v_and_b32 v16, 0xffff0000, v71
    v_mul_f32 v13, v13, v14
    v_mul_f32 v15, v15, v16
    v_cvt_pk_bf16_f32 v13, v13, v15
    v_lshlrev_b32 v14, 16, v13
    v_and_b32 v15, 0xffff0000, v13
    v_add_f32 v12, v12, v14
    v_add_f32 v12, v12, v15
    v_lshlrev_b32 v13, 16, v40
    v_lshlrev_b32 v14, 16, v72
    v_and_b32 v15, 0xffff0000, v40
    v_and_b32 v16, 0xffff0000, v72
    v_mul_f32 v13, v13, v14
    v_mul_f32 v15, v15, v16
    v_cvt_pk_bf16_f32 v13, v13, v15
    v_lshlrev_b32 v14, 16, v13
    v_and_b32 v15, 0xffff0000, v13
    v_add_f32 v12, v12, v14
    v_add_f32 v12, v12, v15
    v_lshlrev_b32 v13, 16, v41
    v_lshlrev_b32 v14, 16, v73
    v_and_b32 v15, 0xffff0000, v41
    v_and_b32 v16, 0xffff0000, v73
    v_mul_f32 v13, v13, v14
    v_mul_f32 v15, v15, v16
    v_cvt_pk_bf16_f32 v13, v13, v15
    v_lshlrev_b32 v14, 16, v13
    v_and_b32 v15, 0xffff0000, v13
    v_add_f32 v12, v12, v14
    v_add_f32 v12, v12, v15
    v_lshlrev_b32 v13, 16, v42
    v_lshlrev_b32 v14, 16, v74
    v_and_b32 v15, 0xffff0000, v42
    v_and_b32 v16, 0xffff0000, v74
    v_mul_f32 v13, v13, v14
    v_mul_f32 v15, v15, v16
    v_cvt_pk_bf16_f32 v13, v13, v15
    v_lshlrev_b32 v14, 16, v13
    v_and_b32 v15, 0xffff0000, v13
    v_add_f32 v12, v12, v14
    v_add_f32 v12, v12, v15
    v_lshlrev_b32 v13, 16, v43
    v_lshlrev_b32 v14, 16, v75
    v_and_b32 v15, 0xffff0000, v43
    v_and_b32 v16, 0xffff0000, v75
    v_mul_f32 v13, v13, v14
    v_mul_f32 v15, v15, v16
    v_cvt_pk_bf16_f32 v13, v13, v15
    v_lshlrev_b32 v14, 16, v13
    v_and_b32 v15, 0xffff0000, v13
    v_add_f32 v12, v12, v14
    v_add_f32 v12, v12, v15
    v_lshlrev_b32 v13, 16, v44
    v_lshlrev_b32 v14, 16, v76
    v_and_b32 v15, 0xffff0000, v44
    v_and_b32 v16, 0xffff0000, v76
    v_mul_f32 v13, v13, v14
    v_mul_f32 v15, v15, v16
    v_cvt_pk_bf16_f32 v13, v13, v15
    v_lshlrev_b32 v14, 16, v13
    v_and_b32 v15, 0xffff0000, v13
    v_add_f32 v12, v12, v14
    v_add_f32 v12, v12, v15
    v_lshlrev_b32 v13, 16, v45
    v_lshlrev_b32 v14, 16, v77
    v_and_b32 v15, 0xffff0000, v45
    v_and_b32 v16, 0xffff0000, v77
    v_mul_f32 v13, v13, v14
    v_mul_f32 v15, v15, v16
    v_cvt_pk_bf16_f32 v13, v13, v15
    v_lshlrev_b32 v14, 16, v13
    v_and_b32 v15, 0xffff0000, v13
    v_add_f32 v12, v12, v14
    v_add_f32 v12, v12, v15
    v_lshlrev_b32 v13, 16, v46
    v_lshlrev_b32 v14, 16, v78
    v_and_b32 v15, 0xffff0000, v46
    v_and_b32 v16, 0xffff0000, v78
    v_mul_f32 v13, v13, v14
    v_mul_f32 v15, v15, v16
    v_cvt_pk_bf16_f32 v13, v13, v15
    v_lshlrev_b32 v14, 16, v13
    v_and_b32 v15, 0xffff0000, v13
    v_add_f32 v12, v12, v14
    v_add_f32 v12, v12, v15
    v_lshlrev_b32 v13, 16, v47
    v_lshlrev_b32 v14, 16, v79
    v_and_b32 v15, 0xffff0000, v47
    v_and_b32 v16, 0xffff0000, v79
    v_mul_f32 v13, v13, v14
    v_mul_f32 v15, v15, v16
    v_cvt_pk_bf16_f32 v13, v13, v15
    v_lshlrev_b32 v14, 16, v13
    v_and_b32 v15, 0xffff0000, v13
    v_add_f32 v12, v12, v14
    v_add_f32 v12, v12, v15
    v_lshlrev_b32 v13, 16, v48
    v_lshlrev_b32 v14, 16, v80
    v_and_b32 v15, 0xffff0000, v48
    v_and_b32 v16, 0xffff0000, v80
    v_mul_f32 v13, v13, v14
    v_mul_f32 v15, v15, v16
    v_cvt_pk_bf16_f32 v13, v13, v15
    v_lshlrev_b32 v14, 16, v13
    v_and_b32 v15, 0xffff0000, v13
    v_add_f32 v12, v12, v14
    v_add_f32 v12, v12, v15
    v_lshlrev_b32 v13, 16, v49
    v_lshlrev_b32 v14, 16, v81
    v_and_b32 v15, 0xffff0000, v49
    v_and_b32 v16, 0xffff0000, v81
    v_mul_f32 v13, v13, v14
    v_mul_f32 v15, v15, v16
    v_cvt_pk_bf16_f32 v13, v13, v15
    v_lshlrev_b32 v14, 16, v13
    v_and_b32 v15, 0xffff0000, v13
    v_add_f32 v12, v12, v14
    v_add_f32 v12, v12, v15
    v_lshlrev_b32 v13, 16, v50
    v_lshlrev_b32 v14, 16, v82
    v_and_b32 v15, 0xffff0000, v50
    v_and_b32 v16, 0xffff0000, v82
    v_mul_f32 v13, v13, v14
    v_mul_f32 v15, v15, v16
    v_cvt_pk_bf16_f32 v13, v13, v15
    v_lshlrev_b32 v14, 16, v13
    v_and_b32 v15, 0xffff0000, v13
    v_add_f32 v12, v12, v14
    v_add_f32 v12, v12, v15
    v_lshlrev_b32 v13, 16, v51
    v_lshlrev_b32 v14, 16, v83
    v_and_b32 v15, 0xffff0000, v51
    v_and_b32 v16, 0xffff0000, v83
    v_mul_f32 v13, v13, v14
    v_mul_f32 v15, v15, v16
    v_cvt_pk_bf16_f32 v13, v13, v15
    v_lshlrev_b32 v14, 16, v13
    v_and_b32 v15, 0xffff0000, v13
    v_add_f32 v12, v12, v14
    v_add_f32 v12, v12, v15
    s_nop 1
    v_add_f32_dpp v12, v12, v12 quad_perm:[1,0,3,2] row_mask:0xf bank_mask:0xf
    s_nop 1
    v_add_f32_dpp v12, v12, v12 quad_perm:[2,3,0,1] row_mask:0xf bank_mask:0xf
    s_nop 1
    v_add_f32_dpp v12, v12, v12 row_half_mirror row_mask:0xf bank_mask:0xf
    s_nop 1
    v_add_f32_dpp v12, v12, v12 row_mirror row_mask:0xf bank_mask:0xf
    v_cvt_pk_bf16_f32 v12, v12, v12
    v_and_b32 v12, 0xffff0000, v12
    v_mul_f32 v13, 0xbfb8aa3b, v12
    v_exp_f32 v13, v13
    s_nop 0
    v_add_f32 v13, 1.0, v13
    v_rcp_f32 v13, v13
    s_nop 0
    v_cvt_pk_bf16_f32 v13, v13, v13
    v_and_b32 v13, 0xffff0000, v13
    v_sub_f32 v14, 1.0, v13
    v_cvt_pk_bf16_f32 v14, v14, v14
    v_and_b32 v14, 0xffff0000, v14
    v_lshrrev_b32 v9, 4, v1
    v_lshlrev_b32 v9, 2, v9
    s_mov_b32 s21, 1507328
    buffer_store_dword v13, v9, s[52:55], s21 offen
    buffer_store_dword v14, v9, s[52:55], s21 offen offset:16
LP_end:
    s_endpgm
.globl main_kernel
.p2align 8
.type main_kernel,@function
main_kernel:
    s_cmp_ge_u32 s2, 256
    s_cbranch_scc1 L_end
    s_load_dwordx4 s[4:7], s[0:1], 8
    s_load_dwordx2 s[12:13], s[0:1], 32
    s_load_dwordx2 s[68:69], s[0:1], 64
    s_load_dwordx2 s[72:73], s[0:1], 80
    s_load_dwordx2 s[16:17], s[0:1], 96
    v_and_b32 v1, 63, v0
    v_and_b32 v2, 7, v0
    v_bfe_u32 v3, v0, 3, 3
    v_lshrrev_b32 v8, 6, v0
    s_nop 0
    v_readfirstlane_b32 s18, v8
    s_lshr_b32 s19, s2, 3
    s_and_b32 s20, s2, 7
    s_mul_i32 s14, s19, 1
    s_lshr_b32 s21, s20, 3
    s_add_u32 s15, s14, s21
    s_and_b32 s33, s20, 7
    s_mov_b32 s46, 0x3dd53b95
    v_bfe_u32 v8, v1, 5, 1
    v_bfe_u32 v9, v1, 4, 1
    v_lshl_add_u32 v8, v9, 1, v8
    v_lshl_add_u32 v11, v2, 3, v8
    v_mul_u32_u24 v4, 384, v3
    v_lshl_add_u32 v4, v2, 4, v4
    s_waitcnt lgkmcnt(0)
    s_mov_b32 s52, s16
    s_mov_b32 s53, s17
    s_mov_b32 s54, 1900544
    s_mov_b32 s55, 0x20000
    s_mov_b32 s60, s72
    s_mov_b32 s61, s73
    s_mov_b32 s62, 5120
    s_mov_b32 s63, 0x20000
    s_cmp_ge_u32 s18, 8
    s_cbranch_scc1 L_aux
    s_mul_i32 s21, s14, 3145728
    s_add_u32 s36, s4, s21
    s_addc_u32 s37, s5, 0
    s_sub_u32 s38, 402653184, s21
    s_mov_b32 s39, 0x20000
    s_add_u32 s40, s6, s21
    s_addc_u32 s41, s7, 0
    s_mov_b32 s42, s38
    s_mov_b32 s43, 0x20000
    s_lshl_b32 s21, s20, 3
    s_add_u32 s21, s21, s18
    s_mul_i32 s90, s21, 3072
    s_mov_b32 s47, s90
    s_mov_b32 s50, 0
    s_mov_b32 s87, 0
    buffer_load_dwordx4 v[72:75], v4, s[36:39], s47 offen offset:0 nt
    buffer_load_dwordx4 v[76:79], v4, s[36:39], s47 offen offset:128 nt
    buffer_load_dwordx4 v[80:83], v4, s[36:39], s47 offen offset:256 nt
    s_lshl_b32 s21, s19, 8
    s_add_u32 s21, s21, 1572864
    s_add_u32 s88, s16, s21
    s_addc_u32 s89, s17, 0
    s_mov_b32 s86, 1
    s_atomic_add s86, s[88:89], 0 glc
    s_mul_i32 s21, s15, 245760
    s_add_u32 s28, s12, s21
    s_addc_u32 s29, s13, 0
    s_mov_b32 s30, 245760
    s_mov_b32 s31, 0x20000
    s_lshl_b32 s21, s18, 3
    v_add_u32 v8, s21, v3
    v_mul_u32_u24 v9, 1280, v8
    v_lshl_add_u32 v9, v2, 4, v9
    s_lshl_b32 s21, s33, 7
    s_cmp_lt_u32 s33, 2
    s_cselect_b32 s23, 0, 0x10000000
    s_add_u32 s22, s21, 0
    buffer_load_dwordx4 v[96:99], v9, s[28:31], s22 offen
    s_add_u32 s22, s21, 81920
    buffer_load_dwordx4 v[100:103], v9, s[28:31], s22 offen
    s_add_u32 s22, s21, 163840
    buffer_load_dwordx4 v[104:107], v9, s[28:31], s22 offen
    s_add_u32 s22, s21, 1024
    s_add_u32 s22, s22, s23
    buffer_load_dwordx4 v[108:111], v9, s[28:31], s22 offen
    s_add_u32 s22, s21, 82944
    s_add_u32 s22, s22, s23
    buffer_load_dwordx4 v[112:115], v9, s[28:31], s22 offen
    s_add_u32 s22, s21, 164864
    s_add_u32 s22, s22, s23
    buffer_load_dwordx4 v[116:119], v9, s[28:31], s22 offen
    v_mov_b32 v9, 0
    s_mov_b32 s21, 1507328
    buffer_load_dwordx4 v[44:47], v9, s[52:55], s21 offen
    s_cmp_ge_u32 s18, 2
    s_cbranch_scc1 L_noqst
    v_mul_u32_u24 v9, 2731, v0
    v_lshrrev_b32 v9, 16, v9
    v_mul_u32_u24 v10, 24, v9
    v_sub_u32 v10, v0, v10
    v_and_b32 v12, 3, v9
    v_lshrrev_b32 v13, 2, v9
    v_mul_u32_u24 v12, 12288, v12
    v_mul_u32_u24 v13, 384, v13
    v_add_u32 v12, v12, v13
    v_lshl_add_u32 v12, v10, 4, v12
    s_mul_i32 s21, s14, 384
    s_add_u32 s21, s21, 1376256
    v_cmp_gt_u32 vcc, 96, v0
    s_and_saveexec_b64 s[22:23], vcc
    buffer_load_dwordx4 v[16:19], v12, s[52:55], s21 offen
    v_lshlrev_b32 v8, 4, v0
    s_waitcnt vmcnt(0)
    ds_write_b128 v8, v[16:19] offset:24576
    s_mov_b64 exec, s[22:23]
L_noqst:
    v_lshlrev_b32 v8, 2, v1
    s_mul_i32 s21, s18, 768
    v_add_u32 v8, s21, v8
    v_mov_b32 v9, 0
    ds_write_b32 v8, v9 offset:0
    ds_write_b32 v8, v9 offset:256
    ds_write_b32 v8, v9 offset:512
    ds_write_b32 v8, v9 offset:6144
    ds_write_b32 v8, v9 offset:6400
    ds_write_b32 v8, v9 offset:6656
    ds_write_b32 v8, v9 offset:12288
    ds_write_b32 v8, v9 offset:12544
    ds_write_b32 v8, v9 offset:12800
    ds_write_b32 v8, v9 offset:18432
    ds_write_b32 v8, v9 offset:18688
    ds_write_b32 v8, v9 offset:18944
    s_lshl_b32 s21, s18, 3
    v_mov_b32 v10, s21
    v_mov_b32 v8, 0xf149f2ca
    ds_write_b64 v10, v[8:9] offset:26112
    ds_write_b64 v10, v[8:9] offset:26176
    ds_write_b64 v10, v[8:9] offset:26240
    ds_write_b64 v10, v[8:9] offset:26304
    s_waitcnt lgkmcnt(0)
    s_barrier
    v_lshlrev_b32 v8, 4, v2
    s_mul_i32 s21, s50, 384
    v_add_u32 v8, s21, v8
    ds_read_b128 v[20:23], v8 offset:24576
    ds_read_b128 v[24:27], v8 offset:24704
    ds_read_b128 v[28:31], v8 offset:24832
    v_mov_b32 v48, 0
    v_mov_b32 v49, 0
    v_mov_b32 v50, 0
    v_mov_b32 v51, 0
    v_mov_b32 v52, 0
    v_mov_b32 v53, 0
    v_mov_b32 v54, 0
    v_mov_b32 v55, 0
    v_mov_b32 v56, 0
    v_mov_b32 v57, 0
    v_mov_b32 v58, 0
    v_mov_b32 v59, 0
    v_mov_b32 v60, 0
    v_mov_b32 v61, 0
    v_mov_b32 v62, 0
    v_mov_b32 v63, 0
    v_mov_b32 v64, 0
    v_mov_b32 v65, 0
    v_mov_b32 v66, 0
    v_mov_b32 v67, 0
    v_mov_b32 v68, 0
    v_mov_b32 v69, 0
    v_mov_b32 v70, 0
    v_mov_b32 v71, 0
    v_mov_b32 v5, 0xf149f2ca
    v_mov_b32 v6, 0
    s_waitcnt lgkmcnt(0)
L_loop:
    s_waitcnt vmcnt(0)
    buffer_load_dwordx4 v[84:87], v4, s[40:43], s47 offen offset:0 nt
    buffer_load_dwordx4 v[88:91], v4, s[40:43], s47 offen offset:128 nt
    buffer_load_dwordx4 v[92:95], v4, s[40:43], s47 offen offset:256 nt
    v_dot2_f32_bf16 v12, v72, v20, 0
    v_dot2_f32_bf16 v13, v76, v24, 0
    v_dot2_f32_bf16 v14, v80, v28, 0
    v_dot2_f32_bf16 v12, v73, v21, v12
    v_dot2_f32_bf16 v13, v77, v25, v13
    v_dot2_f32_bf16 v14, v81, v29, v14
    v_dot2_f32_bf16 v12, v74, v22, v12
    v_dot2_f32_bf16 v13, v78, v26, v13
    v_dot2_f32_bf16 v14, v82, v30, v14
    v_dot2_f32_bf16 v12, v75, v23, v12
    v_dot2_f32_bf16 v13, v79, v27, v13
    v_dot2_f32_bf16 v14, v83, v31, v14
    s_add_u32 s87, s87, 1
    s_cmp_lg_u32 s87, 30
    s_cbranch_scc1 L_nowarm
    s_cmp_lg_u32 s18, 7
    s_cbranch_scc1 L_nowarm
    s_getpc_b64 s[92:93]
L_pcref:
    s_add_u32 s92, s92, L_done-L_pcref
    s_addc_u32 s93, s93, 0
    v_lshlrev_b32 v8, 4, v1
    global_load_dwordx4 v[120:123], v8, s[92:93] offset:0
    v_add_u32 v8, 1024, v8
    global_load_dwordx4 v[120:123], v8, s[92:93] offset:0
    v_add_u32 v8, 1024, v8
    global_load_dwordx4 v[120:123], v8, s[92:93] offset:0
    v_add_u32 v8, 1024, v8
    global_load_dwordx4 v[120:123], v8, s[92:93] offset:0
    v_add_u32 v8, 1024, v8
    global_load_dwordx4 v[120:123], v8, s[92:93] offset:0
    v_add_u32 v8, 1024, v8
    global_load_dwordx4 v[120:123], v8, s[92:93] offset:0
    v_add_u32 v8, 1024, v8
L_nowarm:
    s_cmp_ge_u32 s87, 56
    s_cbranch_scc1 L_pool
    s_lshr_b32 s51, s87, 4
    s_and_b32 s22, s87, 15
    s_mul_i32 s22, s22, 196608
    s_and_b32 s23, s51, 3
    s_mul_i32 s49, s23, 100663296
    s_lshr_b32 s23, s51, 2
    s_mul_i32 s23, s23, 3145728
    s_add_u32 s49, s49, s23
    s_add_u32 s49, s49, s22
    s_add_u32 s49, s49, s90
    s_branch L_poolj
L_pool:
    s_waitcnt lgkmcnt(0)
    s_mov_b32 s21, s86
    s_mov_b32 s86, 1
    s_atomic_add s86, s[88:89], 0 glc
    s_mov_b32 s51, 3
    s_mul_i32 s49, s21, 3072
    s_add_u32 s49, s49, 303562752
    s_cmp_lt_u32 s21, 512
    s_cselect_b32 s49, s49, 0x30000000
L_poolj:
    v_add_f32 v32, v12, v13
    v_add_f32 v32, v32, v14
    s_nop 1
    v_add_f32_dpp v32, v32, v32 quad_perm:[1,0,3,2] row_mask:0xf bank_mask:0xf
    s_nop 1
    v_add_f32_dpp v32, v32, v32 quad_perm:[2,3,0,1] row_mask:0xf bank_mask:0xf
    s_nop 1
    v_add_f32_dpp v32, v32, v32 row_half_mirror row_mask:0xf bank_mask:0xf
    v_max_f32 v8, v32, v5
    v_sub_f32 v9, v5, v8
    v_mul_f32 v7, s46, v8
    v_mul_f32 v9, s46, v9
    v_mov_b32 v5, v8
    v_exp_f32 v9, v9
    v_fma_f32 v32, v32, s46, -v7
    v_exp_f32 v32, v32
    v_mul_f32 v6, v6, v9
    v_pk_mul_f32 v[48:49], v[48:49], v[8:9] op_sel:[0,1] op_sel_hi:[1,1]
    v_pk_mul_f32 v[50:51], v[50:51], v[8:9] op_sel:[0,1] op_sel_hi:[1,1]
    v_pk_mul_f32 v[52:53], v[52:53], v[8:9] op_sel:[0,1] op_sel_hi:[1,1]
    v_pk_mul_f32 v[54:55], v[54:55], v[8:9] op_sel:[0,1] op_sel_hi:[1,1]
    v_pk_mul_f32 v[56:57], v[56:57], v[8:9] op_sel:[0,1] op_sel_hi:[1,1]
    v_pk_mul_f32 v[58:59], v[58:59], v[8:9] op_sel:[0,1] op_sel_hi:[1,1]
    v_pk_mul_f32 v[60:61], v[60:61], v[8:9] op_sel:[0,1] op_sel_hi:[1,1]
    v_pk_mul_f32 v[62:63], v[62:63], v[8:9] op_sel:[0,1] op_sel_hi:[1,1]
    v_pk_mul_f32 v[64:65], v[64:65], v[8:9] op_sel:[0,1] op_sel_hi:[1,1]
    v_pk_mul_f32 v[66:67], v[66:67], v[8:9] op_sel:[0,1] op_sel_hi:[1,1]
    v_pk_mul_f32 v[68:69], v[68:69], v[8:9] op_sel:[0,1] op_sel_hi:[1,1]
    v_pk_mul_f32 v[70:71], v[70:71], v[8:9] op_sel:[0,1] op_sel_hi:[1,1]
    v_add_f32 v6, v6, v32
    v_cvt_pk_bf16_f32 v32, v32, 0
    v_lshlrev_b32 v18, 16, v32
    s_waitcnt vmcnt(0)
    buffer_load_dwordx4 v[72:75], v4, s[36:39], s49 offen offset:0 nt
    buffer_load_dwordx4 v[76:79], v4, s[36:39], s49 offen offset:128 nt
    buffer_load_dwordx4 v[80:83], v4, s[36:39], s49 offen offset:256 nt
    v_dot2c_f32_bf16 v48, v84, v32
    v_dot2c_f32_bf16 v50, v85, v32
    v_dot2c_f32_bf16 v52, v86, v32
    v_dot2c_f32_bf16 v54, v87, v32
    v_dot2c_f32_bf16 v56, v88, v32
    v_dot2c_f32_bf16 v58, v89, v32
    v_dot2c_f32_bf16 v60, v90, v32
    v_dot2c_f32_bf16 v62, v91, v32
    v_dot2c_f32_bf16 v64, v92, v32
    v_dot2c_f32_bf16 v66, v93, v32
    v_dot2c_f32_bf16 v68, v94, v32
    v_dot2c_f32_bf16 v70, v95, v32
    v_dot2c_f32_bf16 v49, v84, v18
    v_dot2c_f32_bf16 v51, v85, v18
    v_dot2c_f32_bf16 v53, v86, v18
    v_dot2c_f32_bf16 v55, v87, v18
    v_dot2c_f32_bf16 v57, v88, v18
    v_dot2c_f32_bf16 v59, v89, v18
    v_dot2c_f32_bf16 v61, v90, v18
    v_dot2c_f32_bf16 v63, v91, v18
    v_dot2c_f32_bf16 v65, v92, v18
    v_dot2c_f32_bf16 v67, v93, v18
    v_dot2c_f32_bf16 v69, v94, v18
    v_dot2c_f32_bf16 v71, v95, v18
    s_cmp_eq_u32 s49, 0x30000000
    s_cbranch_scc1 L_done
    s_mov_b32 s47, s49
    s_cmp_eq_u32 s51, s50
    s_cbranch_scc1 L_loop
    s_nop 0
    v_mov_b32 v8, v5
    s_nop 1
    v_max_f32_dpp v8, v8, v8 row_ror:8 row_mask:0xf bank_mask:0xf
    v_mov_b32 v9, v8
    s_nop 1
    v_permlane16_swap_b32 v8, v9
    s_nop 0
    v_max_f32 v8, v8, v9
    v_mov_b32 v9, v8
    s_nop 1
    v_permlane32_swap_b32 v8, v9
    s_nop 0
    v_max_f32 v8, v8, v9
    v_sub_f32 v9, v5, v8
    v_mul_f32 v9, s46, v9
    v_exp_f32 v9, v9
    s_nop 0
    v_mul_f32 v6, v6, v9
    v_pk_mul_f32 v[48:49], v[48:49], v[8:9] op_sel:[0,1] op_sel_hi:[1,1]
    v_pk_mul_f32 v[50:51], v[50:51], v[8:9] op_sel:[0,1] op_sel_hi:[1,1]
    v_pk_mul_f32 v[52:53], v[52:53], v[8:9] op_sel:[0,1] op_sel_hi:[1,1]
    v_pk_mul_f32 v[54:55], v[54:55], v[8:9] op_sel:[0,1] op_sel_hi:[1,1]
    v_pk_mul_f32 v[56:57], v[56:57], v[8:9] op_sel:[0,1] op_sel_hi:[1,1]
    v_pk_mul_f32 v[58:59], v[58:59], v[8:9] op_sel:[0,1] op_sel_hi:[1,1]
    v_pk_mul_f32 v[60:61], v[60:61], v[8:9] op_sel:[0,1] op_sel_hi:[1,1]
    v_pk_mul_f32 v[62:63], v[62:63], v[8:9] op_sel:[0,1] op_sel_hi:[1,1]
    v_pk_mul_f32 v[64:65], v[64:65], v[8:9] op_sel:[0,1] op_sel_hi:[1,1]
    v_pk_mul_f32 v[66:67], v[66:67], v[8:9] op_sel:[0,1] op_sel_hi:[1,1]
    v_pk_mul_f32 v[68:69], v[68:69], v[8:9] op_sel:[0,1] op_sel_hi:[1,1]
    v_pk_mul_f32 v[70:71], v[70:71], v[8:9] op_sel:[0,1] op_sel_hi:[1,1]
    v_add_f32_dpp v6, v6, v6 row_ror:8 row_mask:0xf bank_mask:0xf
    v_mov_b32 v9, v6
    s_nop 1
    v_permlane16_swap_b32 v6, v9
    s_nop 0
    v_add_f32 v6, v6, v9
    v_mov_b32 v9, v6
    s_nop 1
    v_permlane32_swap_b32 v6, v9
    s_nop 0
    v_add_f32 v9, v6, v9
    s_nop 1
    v_permlane32_swap_b32 v48, v49
    v_permlane32_swap_b32 v50, v51
    v_permlane32_swap_b32 v52, v53
    v_permlane32_swap_b32 v54, v55
    v_permlane32_swap_b32 v56, v57
    v_permlane32_swap_b32 v58, v59
    v_permlane32_swap_b32 v60, v61
    v_permlane32_swap_b32 v62, v63
    v_permlane32_swap_b32 v64, v65
    v_permlane32_swap_b32 v66, v67
    v_permlane32_swap_b32 v68, v69
    v_permlane32_swap_b32 v70, v71
    s_nop 0
    v_add_f32 v48, v48, v49
    v_add_f32 v50, v50, v51
    v_add_f32 v52, v52, v53
    v_add_f32 v54, v54, v55
    v_add_f32 v56, v56, v57
    v_add_f32 v58, v58, v59
    v_add_f32 v60, v60, v61
    v_add_f32 v62, v62, v63
    v_add_f32 v64, v64, v65
    v_add_f32 v66, v66, v67
    v_add_f32 v68, v68, v69
    v_add_f32 v70, v70, v71
    s_nop 0
    v_permlane16_swap_b32 v48, v50
    v_permlane16_swap_b32 v52, v54
    v_permlane16_swap_b32 v56, v58
    v_permlane16_swap_b32 v60, v62
    v_permlane16_swap_b32 v64, v66
    v_permlane16_swap_b32 v68, v70
    s_nop 0
    v_add_f32 v48, v48, v50
    v_add_f32 v52, v52, v54
    v_add_f32 v56, v56, v58
    v_add_f32 v60, v60, v62
    v_add_f32 v64, v64, v66
    v_add_f32 v68, v68, v70
    s_nop 0
    v_add_f32_dpp v48, v48, v48 row_ror:8 row_mask:0xf bank_mask:0xf
    v_add_f32_dpp v52, v52, v52 row_ror:8 row_mask:0xf bank_mask:0xf
    v_add_f32_dpp v56, v56, v56 row_ror:8 row_mask:0xf bank_mask:0xf
    v_add_f32_dpp v60, v60, v60 row_ror:8 row_mask:0xf bank_mask:0xf
    v_add_f32_dpp v64, v64, v64 row_ror:8 row_mask:0xf bank_mask:0xf
    v_add_f32_dpp v68, v68, v68 row_ror:8 row_mask:0xf bank_mask:0xf
    v_lshlrev_b32 v10, 2, v11
    s_mul_i32 s21, s50, 6144
    s_mul_i32 s22, s18, 768
    s_add_u32 s21, s21, s22
    v_add_u32 v10, s21, v10
    ds_write_b32 v10, v48 offset:0
    ds_write_b32 v10, v52 offset:16
    ds_write_b32 v10, v56 offset:256
    ds_write_b32 v10, v60 offset:272
    ds_write_b32 v10, v64 offset:512
    ds_write_b32 v10, v68 offset:528
    s_lshl_b32 s21, s50, 6
    s_lshl_b32 s22, s18, 3
    s_add_u32 s21, s21, s22
    v_mov_b32 v10, s21
    ds_write_b64 v10, v[8:9] offset:26112
    s_mov_b32 s50, s51
    v_lshlrev_b32 v8, 4, v2
    s_mul_i32 s21, s50, 384
    v_add_u32 v8, s21, v8
    ds_read_b128 v[20:23], v8 offset:24576
    ds_read_b128 v[24:27], v8 offset:24704
    ds_read_b128 v[28:31], v8 offset:24832
    v_mov_b32 v48, 0
    v_mov_b32 v49, 0
    v_mov_b32 v50, 0
    v_mov_b32 v51, 0
    v_mov_b32 v52, 0
    v_mov_b32 v53, 0
    v_mov_b32 v54, 0
    v_mov_b32 v55, 0
    v_mov_b32 v56, 0
    v_mov_b32 v57, 0
    v_mov_b32 v58, 0
    v_mov_b32 v59, 0
    v_mov_b32 v60, 0
    v_mov_b32 v61, 0
    v_mov_b32 v62, 0
    v_mov_b32 v63, 0
    v_mov_b32 v64, 0
    v_mov_b32 v65, 0
    v_mov_b32 v66, 0
    v_mov_b32 v67, 0
    v_mov_b32 v68, 0
    v_mov_b32 v69, 0
    v_mov_b32 v70, 0
    v_mov_b32 v71, 0
    v_mov_b32 v5, 0xf149f2ca
    v_mov_b32 v6, 0
    s_waitcnt lgkmcnt(0)
    s_branch L_loop
L_done:
    s_nop 0
    v_mov_b32 v8, v5
    s_nop 1
    v_max_f32_dpp v8, v8, v8 row_ror:8 row_mask:0xf bank_mask:0xf
    v_mov_b32 v9, v8
    s_nop 1
    v_permlane16_swap_b32 v8, v9
    s_nop 0
    v_max_f32 v8, v8, v9
    v_mov_b32 v9, v8
    s_nop 1
    v_permlane32_swap_b32 v8, v9
    s_nop 0
    v_max_f32 v8, v8, v9
    v_sub_f32 v9, v5, v8
    v_mul_f32 v9, s46, v9
    v_exp_f32 v9, v9
    s_nop 0
    v_mul_f32 v6, v6, v9
    v_pk_mul_f32 v[48:49], v[48:49], v[8:9] op_sel:[0,1] op_sel_hi:[1,1]
    v_pk_mul_f32 v[50:51], v[50:51], v[8:9] op_sel:[0,1] op_sel_hi:[1,1]
    v_pk_mul_f32 v[52:53], v[52:53], v[8:9] op_sel:[0,1] op_sel_hi:[1,1]
    v_pk_mul_f32 v[54:55], v[54:55], v[8:9] op_sel:[0,1] op_sel_hi:[1,1]
    v_pk_mul_f32 v[56:57], v[56:57], v[8:9] op_sel:[0,1] op_sel_hi:[1,1]
    v_pk_mul_f32 v[58:59], v[58:59], v[8:9] op_sel:[0,1] op_sel_hi:[1,1]
    v_pk_mul_f32 v[60:61], v[60:61], v[8:9] op_sel:[0,1] op_sel_hi:[1,1]
    v_pk_mul_f32 v[62:63], v[62:63], v[8:9] op_sel:[0,1] op_sel_hi:[1,1]
    v_pk_mul_f32 v[64:65], v[64:65], v[8:9] op_sel:[0,1] op_sel_hi:[1,1]
    v_pk_mul_f32 v[66:67], v[66:67], v[8:9] op_sel:[0,1] op_sel_hi:[1,1]
    v_pk_mul_f32 v[68:69], v[68:69], v[8:9] op_sel:[0,1] op_sel_hi:[1,1]
    v_pk_mul_f32 v[70:71], v[70:71], v[8:9] op_sel:[0,1] op_sel_hi:[1,1]
    v_add_f32_dpp v6, v6, v6 row_ror:8 row_mask:0xf bank_mask:0xf
    v_mov_b32 v9, v6
    s_nop 1
    v_permlane16_swap_b32 v6, v9
    s_nop 0
    v_add_f32 v6, v6, v9
    v_mov_b32 v9, v6
    s_nop 1
    v_permlane32_swap_b32 v6, v9
    s_nop 0
    v_add_f32 v9, v6, v9
    s_nop 1
    v_permlane32_swap_b32 v48, v49
    v_permlane32_swap_b32 v50, v51
    v_permlane32_swap_b32 v52, v53
    v_permlane32_swap_b32 v54, v55
    v_permlane32_swap_b32 v56, v57
    v_permlane32_swap_b32 v58, v59
    v_permlane32_swap_b32 v60, v61
    v_permlane32_swap_b32 v62, v63
    v_permlane32_swap_b32 v64, v65
    v_permlane32_swap_b32 v66, v67
    v_permlane32_swap_b32 v68, v69
    v_permlane32_swap_b32 v70, v71
    s_nop 0
    v_add_f32 v48, v48, v49
    v_add_f32 v50, v50, v51
    v_add_f32 v52, v52, v53
    v_add_f32 v54, v54, v55
    v_add_f32 v56, v56, v57
    v_add_f32 v58, v58, v59
    v_add_f32 v60, v60, v61
    v_add_f32 v62, v62, v63
    v_add_f32 v64, v64, v65
    v_add_f32 v66, v66, v67
    v_add_f32 v68, v68, v69
    v_add_f32 v70, v70, v71
    s_nop 0
    v_permlane16_swap_b32 v48, v50
    v_permlane16_swap_b32 v52, v54
    v_permlane16_swap_b32 v56, v58
    v_permlane16_swap_b32 v60, v62
    v_permlane16_swap_b32 v64, v66
    v_permlane16_swap_b32 v68, v70
    s_nop 0
    v_add_f32 v48, v48, v50
    v_add_f32 v52, v52, v54
    v_add_f32 v56, v56, v58
    v_add_f32 v60, v60, v62
    v_add_f32 v64, v64, v66
    v_add_f32 v68, v68, v70
    s_nop 0
    v_add_f32_dpp v48, v48, v48 row_ror:8 row_mask:0xf bank_mask:0xf
    v_add_f32_dpp v52, v52, v52 row_ror:8 row_mask:0xf bank_mask:0xf
    v_add_f32_dpp v56, v56, v56 row_ror:8 row_mask:0xf bank_mask:0xf
    v_add_f32_dpp v60, v60, v60 row_ror:8 row_mask:0xf bank_mask:0xf
    v_add_f32_dpp v64, v64, v64 row_ror:8 row_mask:0xf bank_mask:0xf
    v_add_f32_dpp v68, v68, v68 row_ror:8 row_mask:0xf bank_mask:0xf
    v_lshlrev_b32 v10, 2, v11
    s_mul_i32 s21, s50, 6144
    s_mul_i32 s22, s18, 768
    s_add_u32 s21, s21, s22
    v_add_u32 v10, s21, v10
    ds_write_b32 v10, v48 offset:0
    ds_write_b32 v10, v52 offset:16
    ds_write_b32 v10, v56 offset:256
    ds_write_b32 v10, v60 offset:272
    ds_write_b32 v10, v64 offset:512
    ds_write_b32 v10, v68 offset:528
    s_lshl_b32 s21, s50, 6
    s_lshl_b32 s22, s18, 3
    s_add_u32 s21, s21, s22
    v_mov_b32 v10, s21
    ds_write_b64 v10, v[8:9] offset:26112
    s_waitcnt vmcnt(0) lgkmcnt(0)
    s_barrier
    v_mov_b32 v72, v44
    v_mov_b32 v73, v45
    v_mov_b32 v74, v46
    v_mov_b32 v75, v47
    s_cmp_ge_u32 s18, 4
    s_cbranch_scc1 L_skip_pub
    s_lshl_b32 s21, s18, 6
    v_mov_b32 v8, s21
    ds_read_b128 v[32:35], v8 offset:26112
    ds_read_b128 v[36:39], v8 offset:26128
    ds_read_b128 v[40:43], v8 offset:26144
    ds_read_b128 v[44:47], v8 offset:26160
    v_lshlrev_b32 v9, 2, v1
    s_mul_i32 s21, s18, 6144
    v_add_u32 v9, s21, v9
    ds_read_b32 v48, v9 offset:0
    ds_read_b32 v49, v9 offset:256
    ds_read_b32 v50, v9 offset:512
    ds_read_b32 v51, v9 offset:768
    ds_read_b32 v52, v9 offset:1024
    ds_read_b32 v53, v9 offset:1280
    ds_read_b32 v54, v9 offset:1536
    ds_read_b32 v55, v9 offset:1792
    ds_read_b32 v56, v9 offset:2048
    ds_read_b32 v57, v9 offset:2304
    ds_read_b32 v58, v9 offset:2560
    ds_read_b32 v59, v9 offset:2816
    ds_read_b32 v60, v9 offset:3072
    ds_read_b32 v61, v9 offset:3328
    ds_read_b32 v62, v9 offset:3584
    ds_read_b32 v63, v9 offset:3840
    ds_read_b32 v64, v9 offset:4096
    ds_read_b32 v65, v9 offset:4352
    ds_read_b32 v66, v9 offset:4608
    ds_read_b32 v67, v9 offset:4864
    ds_read_b32 v68, v9 offset:5120
    ds_read_b32 v69, v9 offset:5376
    ds_read_b32 v70, v9 offset:5632
    ds_read_b32 v71, v9 offset:5888
    s_waitcnt lgkmcnt(0)
    v_max3_f32 v12, v32, v34, v36
    v_max3_f32 v12, v12, v38, v40
    v_max3_f32 v12, v12, v42, v44
    v_max_f32 v12, v12, v46
    v_sub_f32 v32, v32, v12
    v_sub_f32 v34, v34, v12
    v_sub_f32 v36, v36, v12
    v_sub_f32 v38, v38, v12
    v_sub_f32 v40, v40, v12
    v_sub_f32 v42, v42, v12
    v_sub_f32 v44, v44, v12
    v_sub_f32 v46, v46, v12
    v_mul_f32 v32, s46, v32
    v_mul_f32 v34, s46, v34
    v_mul_f32 v36, s46, v36
    v_mul_f32 v38, s46, v38
    v_mul_f32 v40, s46, v40
    v_mul_f32 v42, s46, v42
    v_mul_f32 v44, s46, v44
    v_mul_f32 v46, s46, v46
    v_exp_f32 v32, v32
    v_exp_f32 v34, v34
    v_exp_f32 v36, v36
    v_exp_f32 v38, v38
    v_exp_f32 v40, v40
    v_exp_f32 v42, v42
    v_exp_f32 v44, v44
    v_exp_f32 v46, v46
    s_nop 0
    v_mul_f32 v13, v32, v33
    v_mul_f32 v14, v32, v48
    v_mul_f32 v15, v32, v49
    v_mul_f32 v16, v32, v50
    v_fmac_f32 v13, v34, v35
    v_fmac_f32 v14, v34, v51
    v_fmac_f32 v15, v34, v52
    v_fmac_f32 v16, v34, v53
    v_fmac_f32 v13, v36, v37
    v_fmac_f32 v14, v36, v54
    v_fmac_f32 v15, v36, v55
    v_fmac_f32 v16, v36, v56
    v_fmac_f32 v13, v38, v39
    v_fmac_f32 v14, v38, v57
    v_fmac_f32 v15, v38, v58
    v_fmac_f32 v16, v38, v59
    v_fmac_f32 v13, v40, v41
    v_fmac_f32 v14, v40, v60
    v_fmac_f32 v15, v40, v61
    v_fmac_f32 v16, v40, v62
    v_fmac_f32 v13, v42, v43
    v_fmac_f32 v14, v42, v63
    v_fmac_f32 v15, v42, v64
    v_fmac_f32 v16, v42, v65
    v_fmac_f32 v13, v44, v45
    v_fmac_f32 v14, v44, v66
    v_fmac_f32 v15, v44, v67
    v_fmac_f32 v16, v44, v68
    v_fmac_f32 v13, v46, v47
    v_fmac_f32 v14, v46, v69
    v_fmac_f32 v15, v46, v70
    v_fmac_f32 v16, v46, v71
    s_lshl_b32 s21, s14, 2
    s_add_u32 s21, s21, s18
    s_mul_i32 s21, s21, 8
    s_add_u32 s21, s21, s20
    s_mul_i32 s22, s21, 768
    v_lshlrev_b32 v9, 2, v1
    buffer_store_dword v14, v9, s[52:55], s22 offen offset:0 sc1
    buffer_store_dword v15, v9, s[52:55], s22 offen offset:256 sc1
    buffer_store_dword v16, v9, s[52:55], s22 offen offset:512 sc1
    s_lshl_b32 s21, s21, 3
    s_add_u32 s21, s21, 786432
    v_mov_b32 v9, 0
    v_cmp_eq_u32 vcc, 0, v1
    s_and_saveexec_b64 s[44:45], vcc
    buffer_store_dwordx2 v[12:13], v9, s[52:55], s21 offen sc1
    s_mov_b64 exec, s[44:45]
L_skip_pub:
    s_cmp_ge_u32 s18, 4
    s_cbranch_scc1 L_skip_gm
    s_mov_b32 s23, 0
    s_lshl_b32 s24, s15, 2
    s_add_u32 s24, s24, s18
    s_mul_i32 s24, s24, 8
L_pollP:
    s_lshl_b32 s21, s24, 3
    s_add_u32 s21, s21, 786432
    v_mov_b32 v9, 0
    buffer_load_dwordx4 v[32:35], v9, s[52:55], s21 offen offset:0 sc1
    buffer_load_dwordx4 v[36:39], v9, s[52:55], s21 offen offset:16 sc1
    buffer_load_dwordx4 v[40:43], v9, s[52:55], s21 offen offset:32 sc1
    buffer_load_dwordx4 v[44:47], v9, s[52:55], s21 offen offset:48 sc1
    s_mul_i32 s21, s24, 768
    v_lshlrev_b32 v9, 2, v1
    s_add_u32 s22, s21, 0
    buffer_load_dword v48, v9, s[52:55], s22 offen offset:0 sc1
    buffer_load_dword v49, v9, s[52:55], s22 offen offset:256 sc1
    buffer_load_dword v50, v9, s[52:55], s22 offen offset:512 sc1
    s_add_u32 s22, s21, 768
    buffer_load_dword v51, v9, s[52:55], s22 offen offset:0 sc1
    buffer_load_dword v52, v9, s[52:55], s22 offen offset:256 sc1
    buffer_load_dword v53, v9, s[52:55], s22 offen offset:512 sc1
    s_add_u32 s22, s21, 1536
    buffer_load_dword v54, v9, s[52:55], s22 offen offset:0 sc1
    buffer_load_dword v55, v9, s[52:55], s22 offen offset:256 sc1
    buffer_load_dword v56, v9, s[52:55], s22 offen offset:512 sc1
    s_add_u32 s22, s21, 2304
    buffer_load_dword v57, v9, s[52:55], s22 offen offset:0 sc1
    buffer_load_dword v58, v9, s[52:55], s22 offen offset:256 sc1
    buffer_load_dword v59, v9, s[52:55], s22 offen offset:512 sc1
    s_add_u32 s22, s21, 3072
    buffer_load_dword v60, v9, s[52:55], s22 offen offset:0 sc1
    buffer_load_dword v61, v9, s[52:55], s22 offen offset:256 sc1
    buffer_load_dword v62, v9, s[52:55], s22 offen offset:512 sc1
    s_add_u32 s22, s21, 3840
    buffer_load_dword v63, v9, s[52:55], s22 offen offset:0 sc1
    buffer_load_dword v64, v9, s[52:55], s22 offen offset:256 sc1
    buffer_load_dword v65, v9, s[52:55], s22 offen offset:512 sc1
    s_add_u32 s22, s21, 4608
    buffer_load_dword v66, v9, s[52:55], s22 offen offset:0 sc1
    buffer_load_dword v67, v9, s[52:55], s22 offen offset:256 sc1
    buffer_load_dword v68, v9, s[52:55], s22 offen offset:512 sc1
    s_add_u32 s22, s21, 5376
    buffer_load_dword v69, v9, s[52:55], s22 offen offset:0 sc1
    buffer_load_dword v70, v9, s[52:55], s22 offen offset:256 sc1
    buffer_load_dword v71, v9, s[52:55], s22 offen offset:512 sc1
    s_waitcnt vmcnt(0)
    v_max3_u32 v8, v32, v33, v34
    v_max3_u32 v8, v35, v36, v8
    v_max3_u32 v8, v37, v38, v8
    v_max3_u32 v8, v39, v40, v8
    v_max3_u32 v8, v41, v42, v8
    v_max3_u32 v8, v43, v44, v8
    v_max3_u32 v8, v45, v46, v8
    v_max3_u32 v8, v47, v48, v8
    v_max3_u32 v8, v49, v50, v8
    v_max3_u32 v8, v51, v52, v8
    v_max3_u32 v8, v53, v54, v8
    v_max3_u32 v8, v55, v56, v8
    v_max3_u32 v8, v57, v58, v8
    v_max3_u32 v8, v59, v60, v8
    v_max3_u32 v8, v61, v62, v8
    v_max3_u32 v8, v63, v64, v8
    v_max3_u32 v8, v65, v66, v8
    v_max3_u32 v8, v67, v68, v8
    v_max3_u32 v8, v69, v70, v8
    v_max_u32 v8, v71, v8
    v_cmp_eq_u32 vcc, -1, v8
    s_add_u32 s23, s23, 1
    s_cbranch_vccz L_pollP_done
    s_sleep 1
    s_cmp_lt_u32 s23, 0x40000
    s_cbranch_scc1 L_pollP
L_pollP_done:
    v_max3_f32 v12, v32, v34, v36
    v_max3_f32 v12, v12, v38, v40
    v_max3_f32 v12, v12, v42, v44
    v_max_f32 v12, v12, v46
    v_sub_f32 v32, v32, v12
    v_sub_f32 v34, v34, v12
    v_sub_f32 v36, v36, v12
    v_sub_f32 v38, v38, v12
    v_sub_f32 v40, v40, v12
    v_sub_f32 v42, v42, v12
    v_sub_f32 v44, v44, v12
    v_sub_f32 v46, v46, v12
    v_mul_f32 v32, s46, v32
    v_mul_f32 v34, s46, v34
    v_mul_f32 v36, s46, v36
    v_mul_f32 v38, s46, v38
    v_mul_f32 v40, s46, v40
    v_mul_f32 v42, s46, v42
    v_mul_f32 v44, s46, v44
    v_mul_f32 v46, s46, v46
    v_exp_f32 v32, v32
    v_exp_f32 v34, v34
    v_exp_f32 v36, v36
    v_exp_f32 v38, v38
    v_exp_f32 v40, v40
    v_exp_f32 v42, v42
    v_exp_f32 v44, v44
    v_exp_f32 v46, v46
    s_nop 0
    v_mul_f32 v13, v32, v33
    v_mul_f32 v14, v32, v48
    v_mul_f32 v15, v32, v49
    v_mul_f32 v16, v32, v50
    v_fmac_f32 v13, v34, v35
    v_fmac_f32 v14, v34, v51
    v_fmac_f32 v15, v34, v52
    v_fmac_f32 v16, v34, v53
    v_fmac_f32 v13, v36, v37
    v_fmac_f32 v14, v36, v54
    v_fmac_f32 v15, v36, v55
    v_fmac_f32 v16, v36, v56
    v_fmac_f32 v13, v38, v39
    v_fmac_f32 v14, v38, v57
    v_fmac_f32 v15, v38, v58
    v_fmac_f32 v16, v38, v59
    v_fmac_f32 v13, v40, v41
    v_fmac_f32 v14, v40, v60
    v_fmac_f32 v15, v40, v61
    v_fmac_f32 v16, v40, v62
    v_fmac_f32 v13, v42, v43
    v_fmac_f32 v14, v42, v63
    v_fmac_f32 v15, v42, v64
    v_fmac_f32 v16, v42, v65
    v_fmac_f32 v13, v44, v45
    v_fmac_f32 v14, v44, v66
    v_fmac_f32 v15, v44, v67
    v_fmac_f32 v16, v44, v68
    v_fmac_f32 v13, v46, v47
    v_fmac_f32 v14, v46, v69
    v_fmac_f32 v15, v46, v70
    v_fmac_f32 v16, v46, v71
    v_rcp_f32 v13, v13
    s_nop 0
    v_lshlrev_b32 v9, 4, v1
    s_lshl_b32 s21, s18, 2
    v_add_u32 v9, s21, v9
    v_mul_f32 v14, v14, v13
    v_cvt_pk_bf16_f32 v14, v14, 0
    ds_write_b32 v9, v14 offset:26368
    v_mul_f32 v15, v15, v13
    v_cvt_pk_bf16_f32 v15, v15, 0
    ds_write_b32 v9, v15 offset:27392
    v_mul_f32 v16, v16, v13
    v_cvt_pk_bf16_f32 v16, v16, 0
    ds_write_b32 v9, v16 offset:28416
    s_waitcnt lgkmcnt(0)
L_skip_gm:
    v_mov_b32 v24, v72
    v_mov_b32 v25, v73
    v_mov_b32 v26, v74
    v_mov_b32 v27, v75
    s_barrier
    s_lshl_b32 s21, s18, 3
    v_add_u32 v8, s21, v3
    v_lshlrev_b32 v8, 4, v8
    v_and_b32 v9, 3, v2
    v_lshl_add_u32 v8, v9, 2, v8
    ds_read_b32 v20, v8 offset:26368
    ds_read_b32 v21, v8 offset:27392
    ds_read_b32 v22, v8 offset:28416
    s_waitcnt vmcnt(0) lgkmcnt(0)
    v_lshlrev_b32 v8, 2, v11
    s_lshl_b32 s21, s18, 10
    v_add_u32 v8, s21, v8
    v_mov_b32 v32, 0
    v_mov_b32 v33, 0
    v_mov_b32 v34, 0
    v_mov_b32 v35, 0
    v_mov_b32 v36, 0
    v_mov_b32 v37, 0
    v_mov_b32 v38, 0
    v_mov_b32 v39, 0
    v_mov_b32 v40, 0
    v_mov_b32 v41, 0
    v_mov_b32 v42, 0
    v_mov_b32 v43, 0
    v_mov_b32 v44, 0
    v_mov_b32 v45, 0
    v_mov_b32 v46, 0
    v_mov_b32 v47, 0
    v_mov_b32 v48, 0
    v_mov_b32 v49, 0
    v_mov_b32 v50, 0
    v_mov_b32 v51, 0
    v_mov_b32 v52, 0
    v_mov_b32 v53, 0
    v_mov_b32 v54, 0
    v_mov_b32 v55, 0
    v_mov_b32 v56, 0
    v_mov_b32 v57, 0
    v_mov_b32 v58, 0
    v_mov_b32 v59, 0
    v_mov_b32 v60, 0
    v_mov_b32 v61, 0
    v_mov_b32 v62, 0
    v_mov_b32 v63, 0
    SLABMAC 32, 96, 20, 30
    SLABMAC 32, 100, 21, 30
    SLABMAC 32, 104, 22, 30
    s_nop 2
    s_nop 1
    v_permlane32_swap_b32 v32, v33
    v_permlane32_swap_b32 v34, v35
    v_permlane32_swap_b32 v36, v37
    v_permlane32_swap_b32 v38, v39
    v_permlane32_swap_b32 v40, v41
    v_permlane32_swap_b32 v42, v43
    v_permlane32_swap_b32 v44, v45
    v_permlane32_swap_b32 v46, v47
    v_permlane32_swap_b32 v48, v49
    v_permlane32_swap_b32 v50, v51
    v_permlane32_swap_b32 v52, v53
    v_permlane32_swap_b32 v54, v55
    v_permlane32_swap_b32 v56, v57
    v_permlane32_swap_b32 v58, v59
    v_permlane32_swap_b32 v60, v61
    v_permlane32_swap_b32 v62, v63
    s_nop 0
    v_add_f32 v32, v32, v33
    v_add_f32 v34, v34, v35
    v_add_f32 v36, v36, v37
    v_add_f32 v38, v38, v39
    v_add_f32 v40, v40, v41
    v_add_f32 v42, v42, v43
    v_add_f32 v44, v44, v45
    v_add_f32 v46, v46, v47
    v_add_f32 v48, v48, v49
    v_add_f32 v50, v50, v51
    v_add_f32 v52, v52, v53
    v_add_f32 v54, v54, v55
    v_add_f32 v56, v56, v57
    v_add_f32 v58, v58, v59
    v_add_f32 v60, v60, v61
    v_add_f32 v62, v62, v63
    s_nop 0
    v_permlane16_swap_b32 v32, v34
    v_permlane16_swap_b32 v36, v38
    v_permlane16_swap_b32 v40, v42
    v_permlane16_swap_b32 v44, v46
    v_permlane16_swap_b32 v48, v50
    v_permlane16_swap_b32 v52, v54
    v_permlane16_swap_b32 v56, v58
    v_permlane16_swap_b32 v60, v62
    s_nop 0
    v_add_f32 v32, v32, v34
    v_add_f32 v36, v36, v38
    v_add_f32 v40, v40, v42
    v_add_f32 v44, v44, v46
    v_add_f32 v48, v48, v50
    v_add_f32 v52, v52, v54
    v_add_f32 v56, v56, v58
    v_add_f32 v60, v60, v62
    s_nop 0
    v_add_f32_dpp v32, v32, v32 row_ror:8 row_mask:0xf bank_mask:0xf
    v_add_f32_dpp v36, v36, v36 row_ror:8 row_mask:0xf bank_mask:0xf
    v_add_f32_dpp v40, v40, v40 row_ror:8 row_mask:0xf bank_mask:0xf
    v_add_f32_dpp v44, v44, v44 row_ror:8 row_mask:0xf bank_mask:0xf
    v_add_f32_dpp v48, v48, v48 row_ror:8 row_mask:0xf bank_mask:0xf
    v_add_f32_dpp v52, v52, v52 row_ror:8 row_mask:0xf bank_mask:0xf
    v_add_f32_dpp v56, v56, v56 row_ror:8 row_mask:0xf bank_mask:0xf
    v_add_f32_dpp v60, v60, v60 row_ror:8 row_mask:0xf bank_mask:0xf
    v_mul_f32 v32, v32, v24
    v_mul_f32 v36, v36, v24
    v_mul_f32 v40, v40, v25
    v_mul_f32 v44, v44, v25
    v_mul_f32 v48, v48, v26
    v_mul_f32 v52, v52, v26
    v_mul_f32 v56, v56, v27
    v_mul_f32 v60, v60, v27
    ds_write_b32 v8, v32 offset:0
    ds_write_b32 v8, v36 offset:16
    ds_write_b32 v8, v40 offset:256
    ds_write_b32 v8, v44 offset:272
    ds_write_b32 v8, v48 offset:512
    ds_write_b32 v8, v52 offset:528
    ds_write_b32 v8, v56 offset:768
    ds_write_b32 v8, v60 offset:784
    s_cmp_ge_u32 s33, 2
    s_cbranch_scc1 L_skip_u2
    v_mov_b32 v32, 0
    v_mov_b32 v33, 0
    v_mov_b32 v34, 0
    v_mov_b32 v35, 0
    v_mov_b32 v36, 0
    v_mov_b32 v37, 0
    v_mov_b32 v38, 0
    v_mov_b32 v39, 0
    v_mov_b32 v40, 0
    v_mov_b32 v41, 0
    v_mov_b32 v42, 0
    v_mov_b32 v43, 0
    v_mov_b32 v44, 0
    v_mov_b32 v45, 0
    v_mov_b32 v46, 0
    v_mov_b32 v47, 0
    v_mov_b32 v48, 0
    v_mov_b32 v49, 0
    v_mov_b32 v50, 0
    v_mov_b32 v51, 0
    v_mov_b32 v52, 0
    v_mov_b32 v53, 0
    v_mov_b32 v54, 0
    v_mov_b32 v55, 0
    v_mov_b32 v56, 0
    v_mov_b32 v57, 0
    v_mov_b32 v58, 0
    v_mov_b32 v59, 0
    v_mov_b32 v60, 0
    v_mov_b32 v61, 0
    v_mov_b32 v62, 0
    v_mov_b32 v63, 0
    SLABMAC 32, 108, 20, 30
    SLABMAC 32, 112, 21, 30
    SLABMAC 32, 116, 22, 30
    s_nop 2
    s_nop 1
    v_permlane32_swap_b32 v32, v33
    v_permlane32_swap_b32 v34, v35
    v_permlane32_swap_b32 v36, v37
    v_permlane32_swap_b32 v38, v39
    v_permlane32_swap_b32 v40, v41
    v_permlane32_swap_b32 v42, v43
    v_permlane32_swap_b32 v44, v45
    v_permlane32_swap_b32 v46, v47
    v_permlane32_swap_b32 v48, v49
    v_permlane32_swap_b32 v50, v51
    v_permlane32_swap_b32 v52, v53
    v_permlane32_swap_b32 v54, v55
    v_permlane32_swap_b32 v56, v57
    v_permlane32_swap_b32 v58, v59
    v_permlane32_swap_b32 v60, v61
    v_permlane32_swap_b32 v62, v63
    s_nop 0
    v_add_f32 v32, v32, v33
    v_add_f32 v34, v34, v35
    v_add_f32 v36, v36, v37
    v_add_f32 v38, v38, v39
    v_add_f32 v40, v40, v41
    v_add_f32 v42, v42, v43
    v_add_f32 v44, v44, v45
    v_add_f32 v46, v46, v47
    v_add_f32 v48, v48, v49
    v_add_f32 v50, v50, v51
    v_add_f32 v52, v52, v53
    v_add_f32 v54, v54, v55
    v_add_f32 v56, v56, v57
    v_add_f32 v58, v58, v59
    v_add_f32 v60, v60, v61
    v_add_f32 v62, v62, v63
    s_nop 0
    v_permlane16_swap_b32 v32, v34
    v_permlane16_swap_b32 v36, v38
    v_permlane16_swap_b32 v40, v42
    v_permlane16_swap_b32 v44, v46
    v_permlane16_swap_b32 v48, v50
    v_permlane16_swap_b32 v52, v54
    v_permlane16_swap_b32 v56, v58
    v_permlane16_swap_b32 v60, v62
    s_nop 0
    v_add_f32 v32, v32, v34
    v_add_f32 v36, v36, v38
    v_add_f32 v40, v40, v42
    v_add_f32 v44, v44, v46
    v_add_f32 v48, v48, v50
    v_add_f32 v52, v52, v54
    v_add_f32 v56, v56, v58
    v_add_f32 v60, v60, v62
    s_nop 0
    v_add_f32_dpp v32, v32, v32 row_ror:8 row_mask:0xf bank_mask:0xf
    v_add_f32_dpp v36, v36, v36 row_ror:8 row_mask:0xf bank_mask:0xf
    v_add_f32_dpp v40, v40, v40 row_ror:8 row_mask:0xf bank_mask:0xf
    v_add_f32_dpp v44, v44, v44 row_ror:8 row_mask:0xf bank_mask:0xf
    v_add_f32_dpp v48, v48, v48 row_ror:8 row_mask:0xf bank_mask:0xf
    v_add_f32_dpp v52, v52, v52 row_ror:8 row_mask:0xf bank_mask:0xf
    v_add_f32_dpp v56, v56, v56 row_ror:8 row_mask:0xf bank_mask:0xf
    v_add_f32_dpp v60, v60, v60 row_ror:8 row_mask:0xf bank_mask:0xf
    v_mul_f32 v32, v32, v24
    v_mul_f32 v36, v36, v24
    v_mul_f32 v40, v40, v25
    v_mul_f32 v44, v44, v25
    v_mul_f32 v48, v48, v26
    v_mul_f32 v52, v52, v26
    v_mul_f32 v56, v56, v27
    v_mul_f32 v60, v60, v27
    ds_write_b32 v8, v32 offset:8192
    ds_write_b32 v8, v36 offset:8208
    ds_write_b32 v8, v40 offset:8448
    ds_write_b32 v8, v44 offset:8464
    ds_write_b32 v8, v48 offset:8704
    ds_write_b32 v8, v52 offset:8720
    ds_write_b32 v8, v56 offset:8960
    ds_write_b32 v8, v60 offset:8976
L_skip_u2:
    s_waitcnt lgkmcnt(0)
    s_barrier
    v_and_b32 v8, 255, v0
    v_lshrrev_b32 v9, 8, v0
    v_lshlrev_b32 v10, 2, v8
    v_lshl_add_u32 v10, v9, 13, v10
    ds_read_b32 v32, v10 offset:0
    ds_read_b32 v33, v10 offset:1024
    ds_read_b32 v34, v10 offset:2048
    ds_read_b32 v35, v10 offset:3072
    ds_read_b32 v36, v10 offset:4096
    ds_read_b32 v37, v10 offset:5120
    ds_read_b32 v38, v10 offset:6144
    ds_read_b32 v39, v10 offset:7168
    v_lshrrev_b32 v12, 6, v8
    s_waitcnt lgkmcnt(0)
    v_add_f32 v32, v32, v33
    v_add_f32 v32, v32, v34
    v_add_f32 v32, v32, v35
    v_add_f32 v32, v32, v36
    v_add_f32 v32, v32, v37
    v_add_f32 v32, v32, v38
    v_add_f32 v32, v32, v39
    v_mul_u32_u24 v12, 2560, v12
    v_and_b32 v13, 63, v8
    v_lshl_add_u32 v12, v13, 2, v12
    v_lshl_add_u32 v12, v9, 11, v12
    s_mul_i32 s21, s15, 10240
    s_lshl_b32 s22, s33, 8
    s_add_u32 s21, s21, s22
    s_add_u32 s21, s21, 794624
    s_cmp_lt_u32 s33, 2
    s_movk_i32 s22, 256
    s_cselect_b32 s22, 512, s22
    v_cmp_gt_u32 vcc, s22, v0
    s_and_saveexec_b64 s[44:45], vcc
    s_cbranch_execz L_skip_ystore
    buffer_store_dword v32, v12, s[52:55], s21 offen sc1
L_skip_ystore:
    s_mov_b64 exec, s[44:45]
    s_cmp_ge_u32 s18, 4
    s_cbranch_scc1 L_end
    s_mul_hi_u32 s76, s2, 165191050
    s_mul_i32 s21, s76, 26
    s_cmp_lg_u32 s21, s2
    s_cbranch_scc1 L_end
    v_lshrrev_b32 v8, 4, v1
    v_mul_u32_u24 v8, 2560, v8
    v_and_b32 v9, 15, v1
    v_lshl_add_u32 v8, v9, 4, v8
    s_lshl_b32 s21, s76, 8
    s_mul_i32 s22, s18, 143360
    s_add_u32 s21, s21, s22
    s_add_u32 s21, s21, 794624
    s_mov_b32 s23, 0
L_pollY:
    s_add_u32 s22, s21, 0
    buffer_load_dwordx4 v[32:35], v8, s[52:55], s22 offen sc1
    s_add_u32 s22, s21, 10240
    buffer_load_dwordx4 v[36:39], v8, s[52:55], s22 offen sc1
    s_add_u32 s22, s21, 20480
    buffer_load_dwordx4 v[40:43], v8, s[52:55], s22 offen sc1
    s_add_u32 s22, s21, 30720
    buffer_load_dwordx4 v[44:47], v8, s[52:55], s22 offen sc1
    s_add_u32 s22, s21, 40960
    buffer_load_dwordx4 v[48:51], v8, s[52:55], s22 offen sc1
    s_add_u32 s22, s21, 51200
    buffer_load_dwordx4 v[52:55], v8, s[52:55], s22 offen sc1
    s_add_u32 s22, s21, 61440
    buffer_load_dwordx4 v[56:59], v8, s[52:55], s22 offen sc1
    s_add_u32 s22, s21, 71680
    buffer_load_dwordx4 v[60:63], v8, s[52:55], s22 offen sc1
    s_add_u32 s22, s21, 81920
    buffer_load_dwordx4 v[64:67], v8, s[52:55], s22 offen sc1
    s_add_u32 s22, s21, 92160
    buffer_load_dwordx4 v[68:71], v8, s[52:55], s22 offen sc1
    s_add_u32 s22, s21, 102400
    buffer_load_dwordx4 v[72:75], v8, s[52:55], s22 offen sc1
    s_add_u32 s22, s21, 112640
    buffer_load_dwordx4 v[76:79], v8, s[52:55], s22 offen sc1
    s_add_u32 s22, s21, 122880
    buffer_load_dwordx4 v[80:83], v8, s[52:55], s22 offen sc1
    s_add_u32 s22, s21, 133120
    buffer_load_dwordx4 v[84:87], v8, s[52:55], s22 offen sc1
    s_waitcnt vmcnt(0)
    v_max3_u32 v12, v32, v33, v34
    v_max3_u32 v12, v35, v36, v12
    v_max3_u32 v12, v37, v38, v12
    v_max3_u32 v12, v39, v40, v12
    v_max3_u32 v12, v41, v42, v12
    v_max3_u32 v12, v43, v44, v12
    v_max3_u32 v12, v45, v46, v12
    v_max3_u32 v12, v47, v48, v12
    v_max3_u32 v12, v49, v50, v12
    v_max3_u32 v12, v51, v52, v12
    v_max3_u32 v12, v53, v54, v12
    v_max3_u32 v12, v55, v56, v12
    v_max3_u32 v12, v57, v58, v12
    v_max3_u32 v12, v59, v60, v12
    v_max3_u32 v12, v61, v62, v12
    v_max3_u32 v12, v63, v64, v12
    v_max3_u32 v12, v65, v66, v12
    v_max3_u32 v12, v67, v68, v12
    v_max3_u32 v12, v69, v70, v12
    v_max3_u32 v12, v71, v72, v12
    v_max3_u32 v12, v73, v74, v12
    v_max3_u32 v12, v75, v76, v12
    v_max3_u32 v12, v77, v78, v12
    v_max3_u32 v12, v79, v80, v12
    v_max3_u32 v12, v81, v82, v12
    v_max3_u32 v12, v83, v84, v12
    v_max3_u32 v12, v85, v86, v12
    v_max_u32 v12, v87, v12
    v_cmp_eq_u32 vcc, -1, v12
    s_add_u32 s23, s23, 1
    s_cbranch_vccz L_pollY_done
    s_sleep 1
    s_cmp_lt_u32 s23, 0x40000
    s_cbranch_scc1 L_pollY
L_pollY_done:
    v_add_f32 v12, v32, v36
    v_add_f32 v13, v33, v37
    v_add_f32 v14, v34, v38
    v_add_f32 v15, v35, v39
    v_add_f32 v12, v12, v40
    v_add_f32 v13, v13, v41
    v_add_f32 v14, v14, v42
    v_add_f32 v15, v15, v43
    v_add_f32 v12, v12, v44
    v_add_f32 v13, v13, v45
    v_add_f32 v14, v14, v46
    v_add_f32 v15, v15, v47
    v_add_f32 v12, v12, v48
    v_add_f32 v13, v13, v49
    v_add_f32 v14, v14, v50
    v_add_f32 v15, v15, v51
    v_add_f32 v12, v12, v52
    v_add_f32 v13, v13, v53
    v_add_f32 v14, v14, v54
    v_add_f32 v15, v15, v55
    v_add_f32 v12, v12, v56
    v_add_f32 v13, v13, v57
    v_add_f32 v14, v14, v58
    v_add_f32 v15, v15, v59
    v_add_f32 v12, v12, v60
    v_add_f32 v13, v13, v61
    v_add_f32 v14, v14, v62
    v_add_f32 v15, v15, v63
    v_add_f32 v12, v12, v64
    v_add_f32 v13, v13, v65
    v_add_f32 v14, v14, v66
    v_add_f32 v15, v15, v67
    v_add_f32 v12, v12, v68
    v_add_f32 v13, v13, v69
    v_add_f32 v14, v14, v70
    v_add_f32 v15, v15, v71
    v_add_f32 v12, v12, v72
    v_add_f32 v13, v13, v73
    v_add_f32 v14, v14, v74
    v_add_f32 v15, v15, v75
    v_add_f32 v12, v12, v76
    v_add_f32 v13, v13, v77
    v_add_f32 v14, v14, v78
    v_add_f32 v15, v15, v79
    v_add_f32 v12, v12, v80
    v_add_f32 v13, v13, v81
    v_add_f32 v14, v14, v82
    v_add_f32 v15, v15, v83
    v_add_f32 v12, v12, v84
    v_add_f32 v13, v13, v85
    v_add_f32 v14, v14, v86
    v_add_f32 v15, v15, v87
    v_lshlrev_b32 v9, 4, v1
    s_lshl_b32 s21, s18, 10
    v_add_u32 v10, s21, v9
    ds_write_b128 v10, v[12:15] offset:16384
    s_waitcnt lgkmcnt(0)
    s_barrier
    s_cmp_lg_u32 s18, 0
    s_cbranch_scc1 L_end
    ds_read_b128 v[32:35], v9 offset:16384
    ds_read_b128 v[36:39], v9 offset:17408
    ds_read_b128 v[40:43], v9 offset:18432
    ds_read_b128 v[44:47], v9 offset:19456
    s_waitcnt lgkmcnt(0)
    v_add_f32 v12, v32, v36
    v_add_f32 v16, v40, v44
    v_add_f32 v12, v12, v16
    v_add_f32 v13, v33, v37
    v_add_f32 v17, v41, v45
    v_add_f32 v13, v13, v17
    v_add_f32 v14, v34, v38
    v_add_f32 v18, v42, v46
    v_add_f32 v14, v14, v18
    v_add_f32 v15, v35, v39
    v_add_f32 v19, v43, v47
    v_add_f32 v15, v15, v19
    v_cvt_pk_bf16_f32 v12, v12, v13
    v_cvt_pk_bf16_f32 v13, v14, v15
    v_lshrrev_b32 v8, 1, v8
    s_lshl_b32 s21, s76, 7
    buffer_store_dwordx2 v[12:13], v8, s[60:63], s21 offen
    s_endpgm
L_aux:
    s_barrier
    s_cmp_ge_u32 s2, 240
    s_cbranch_scc1 L_end
    s_mul_hi_u32 s78, s2, 429496730
    s_mul_i32 s22, s78, 10
    s_sub_u32 s79, s2, s22
    s_mul_i32 s21, s78, 81920
    s_add_u32 s24, s68, s21
    s_addc_u32 s25, s69, 0
    s_mov_b32 s26, 81920
    s_mov_b32 s27, 0x20000
    v_mul_u32_u24 v6, 1280, v3
    v_lshl_add_u32 v6, v2, 4, v6
    s_lshl_b32 s21, s79, 7
    s_add_u32 s22, s21, 0
    buffer_load_dwordx4 v[64:67], v6, s[24:27], s22 offen
    s_add_u32 s22, s21, 10240
    buffer_load_dwordx4 v[68:71], v6, s[24:27], s22 offen
    s_add_u32 s22, s21, 20480
    buffer_load_dwordx4 v[72:75], v6, s[24:27], s22 offen
    s_add_u32 s22, s21, 30720
    buffer_load_dwordx4 v[76:79], v6, s[24:27], s22 offen
    s_add_u32 s22, s21, 40960
    buffer_load_dwordx4 v[80:83], v6, s[24:27], s22 offen
    s_add_u32 s22, s21, 51200
    buffer_load_dwordx4 v[84:87], v6, s[24:27], s22 offen
    s_add_u32 s22, s21, 61440
    buffer_load_dwordx4 v[88:91], v6, s[24:27], s22 offen
    s_add_u32 s22, s21, 71680
    buffer_load_dwordx4 v[92:95], v6, s[24:27], s22 offen
    v_lshrrev_b32 v8, 4, v1
    v_mul_u32_u24 v8, 6144, v8
    v_and_b32 v9, 15, v1
    v_lshl_add_u32 v8, v9, 4, v8
    s_lshl_b32 s21, s78, 8
    s_add_u32 s21, s21, 1441792
    buffer_load_dwordx4 v[96:99], v8, s[52:55], s21 offen
    s_add_u32 s21, s21, 24576
    buffer_load_dwordx4 v[100:103], v8, s[52:55], s21 offen
    v_mov_b32 v9, 0
    s_mov_b32 s21, 1507344
    buffer_load_dwordx4 v[24:27], v9, s[52:55], s21 offen
    s_waitcnt vmcnt(0)
    v_and_b32 v5, 15, v1
    v_lshlrev_b32 v5, 6, v5
    v_lshrrev_b32 v9, 4, v1
    v_lshl_add_u32 v5, v9, 2, v5
    v_cvt_pk_bf16_f32 v8, v96, v100
    v_lshlrev_b32 v9, 16, v8
    v_and_b32 v10, 0xffff0000, v8
    v_mul_f32 v13, v9, v9
    v_mov_b32 v12, 0x3d372713
    v_fma_f32 v13, v13, v12, 1.0
    v_mul_f32 v13, v13, v9
    v_mul_f32 v13, 0xc0135761, v13
    v_exp_f32 v13, v13
    s_nop 0
    v_add_f32 v13, 1.0, v13
    v_rcp_f32 v13, v13
    s_nop 0
    v_mul_f32 v13, v13, v9
    v_cvt_pk_bf16_f32 v13, v13, v13
    v_and_b32 v13, 0xffff0000, v13
    v_mul_f32 v12, v13, v10
    v_cvt_pk_bf16_f32 v12, v12, 0
    ds_write_b32 v5, v12 offset:29440
    v_cvt_pk_bf16_f32 v8, v97, v101
    v_lshlrev_b32 v9, 16, v8
    v_and_b32 v10, 0xffff0000, v8
    v_mul_f32 v13, v9, v9
    v_mov_b32 v12, 0x3d372713
    v_fma_f32 v13, v13, v12, 1.0
    v_mul_f32 v13, v13, v9
    v_mul_f32 v13, 0xc0135761, v13
    v_exp_f32 v13, v13
    s_nop 0
    v_add_f32 v13, 1.0, v13
    v_rcp_f32 v13, v13
    s_nop 0
    v_mul_f32 v13, v13, v9
    v_cvt_pk_bf16_f32 v13, v13, v13
    v_and_b32 v13, 0xffff0000, v13
    v_mul_f32 v12, v13, v10
    v_cvt_pk_bf16_f32 v12, v12, 0
    ds_write_b32 v5, v12 offset:29456
    v_cvt_pk_bf16_f32 v8, v98, v102
    v_lshlrev_b32 v9, 16, v8
    v_and_b32 v10, 0xffff0000, v8
    v_mul_f32 v13, v9, v9
    v_mov_b32 v12, 0x3d372713
    v_fma_f32 v13, v13, v12, 1.0
    v_mul_f32 v13, v13, v9
    v_mul_f32 v13, 0xc0135761, v13
    v_exp_f32 v13, v13
    s_nop 0
    v_add_f32 v13, 1.0, v13
    v_rcp_f32 v13, v13
    s_nop 0
    v_mul_f32 v13, v13, v9
    v_cvt_pk_bf16_f32 v13, v13, v13
    v_and_b32 v13, 0xffff0000, v13
    v_mul_f32 v12, v13, v10
    v_cvt_pk_bf16_f32 v12, v12, 0
    ds_write_b32 v5, v12 offset:29472
    v_cvt_pk_bf16_f32 v8, v99, v103
    v_lshlrev_b32 v9, 16, v8
    v_and_b32 v10, 0xffff0000, v8
    v_mul_f32 v13, v9, v9
    v_mov_b32 v12, 0x3d372713
    v_fma_f32 v13, v13, v12, 1.0
    v_mul_f32 v13, v13, v9
    v_mul_f32 v13, 0xc0135761, v13
    v_exp_f32 v13, v13
    s_nop 0
    v_add_f32 v13, 1.0, v13
    v_rcp_f32 v13, v13
    s_nop 0
    v_mul_f32 v13, v13, v9
    v_cvt_pk_bf16_f32 v13, v13, v13
    v_and_b32 v13, 0xffff0000, v13
    v_mul_f32 v12, v13, v10
    v_cvt_pk_bf16_f32 v12, v12, 0
    ds_write_b32 v5, v12 offset:29488
    s_waitcnt lgkmcnt(0)
    v_lshlrev_b32 v5, 4, v3
    v_and_b32 v6, 3, v2
    v_lshl_add_u32 v5, v6, 2, v5
    ds_read_b32 v12, v5 offset:29440
    ds_read_b32 v13, v5 offset:29568
    ds_read_b32 v14, v5 offset:29696
    ds_read_b32 v15, v5 offset:29824
    ds_read_b32 v16, v5 offset:29952
    ds_read_b32 v17, v5 offset:30080
    ds_read_b32 v18, v5 offset:30208
    ds_read_b32 v19, v5 offset:30336
    v_mov_b32 v32, 0
    v_mov_b32 v33, 0
    v_mov_b32 v34, 0
    v_mov_b32 v35, 0
    v_mov_b32 v36, 0
    v_mov_b32 v37, 0
    v_mov_b32 v38, 0
    v_mov_b32 v39, 0
    v_mov_b32 v40, 0
    v_mov_b32 v41, 0
    v_mov_b32 v42, 0
    v_mov_b32 v43, 0
    v_mov_b32 v44, 0
    v_mov_b32 v45, 0
    v_mov_b32 v46, 0
    v_mov_b32 v47, 0
    v_mov_b32 v48, 0
    v_mov_b32 v49, 0
    v_mov_b32 v50, 0
    v_mov_b32 v51, 0
    v_mov_b32 v52, 0
    v_mov_b32 v53, 0
    v_mov_b32 v54, 0
    v_mov_b32 v55, 0
    v_mov_b32 v56, 0
    v_mov_b32 v57, 0
    v_mov_b32 v58, 0
    v_mov_b32 v59, 0
    v_mov_b32 v60, 0
    v_mov_b32 v61, 0
    v_mov_b32 v62, 0
    v_mov_b32 v63, 0
    s_waitcnt lgkmcnt(0)
    SLABMAC 32, 64, 12, 30
    SLABMAC 32, 68, 13, 30
    SLABMAC 32, 72, 14, 30
    SLABMAC 32, 76, 15, 30
    SLABMAC 32, 80, 16, 30
    SLABMAC 32, 84, 17, 30
    SLABMAC 32, 88, 18, 30
    SLABMAC 32, 92, 19, 30
    s_nop 2
    s_nop 1
    v_permlane32_swap_b32 v32, v33
    v_permlane32_swap_b32 v34, v35
    v_permlane32_swap_b32 v36, v37
    v_permlane32_swap_b32 v38, v39
    v_permlane32_swap_b32 v40, v41
    v_permlane32_swap_b32 v42, v43
    v_permlane32_swap_b32 v44, v45
    v_permlane32_swap_b32 v46, v47
    v_permlane32_swap_b32 v48, v49
    v_permlane32_swap_b32 v50, v51
    v_permlane32_swap_b32 v52, v53
    v_permlane32_swap_b32 v54, v55
    v_permlane32_swap_b32 v56, v57
    v_permlane32_swap_b32 v58, v59
    v_permlane32_swap_b32 v60, v61
    v_permlane32_swap_b32 v62, v63
    s_nop 0
    v_add_f32 v32, v32, v33
    v_add_f32 v34, v34, v35
    v_add_f32 v36, v36, v37
    v_add_f32 v38, v38, v39
    v_add_f32 v40, v40, v41
    v_add_f32 v42, v42, v43
    v_add_f32 v44, v44, v45
    v_add_f32 v46, v46, v47
    v_add_f32 v48, v48, v49
    v_add_f32 v50, v50, v51
    v_add_f32 v52, v52, v53
    v_add_f32 v54, v54, v55
    v_add_f32 v56, v56, v57
    v_add_f32 v58, v58, v59
    v_add_f32 v60, v60, v61
    v_add_f32 v62, v62, v63
    s_nop 0
    v_permlane16_swap_b32 v32, v34
    v_permlane16_swap_b32 v36, v38
    v_permlane16_swap_b32 v40, v42
    v_permlane16_swap_b32 v44, v46
    v_permlane16_swap_b32 v48, v50
    v_permlane16_swap_b32 v52, v54
    v_permlane16_swap_b32 v56, v58
    v_permlane16_swap_b32 v60, v62
    s_nop 0
    v_add_f32 v32, v32, v34
    v_add_f32 v36, v36, v38
    v_add_f32 v40, v40, v42
    v_add_f32 v44, v44, v46
    v_add_f32 v48, v48, v50
    v_add_f32 v52, v52, v54
    v_add_f32 v56, v56, v58
    v_add_f32 v60, v60, v62
    s_nop 0
    v_add_f32_dpp v32, v32, v32 row_ror:8 row_mask:0xf bank_mask:0xf
    v_add_f32_dpp v36, v36, v36 row_ror:8 row_mask:0xf bank_mask:0xf
    v_add_f32_dpp v40, v40, v40 row_ror:8 row_mask:0xf bank_mask:0xf
    v_add_f32_dpp v44, v44, v44 row_ror:8 row_mask:0xf bank_mask:0xf
    v_add_f32_dpp v48, v48, v48 row_ror:8 row_mask:0xf bank_mask:0xf
    v_add_f32_dpp v52, v52, v52 row_ror:8 row_mask:0xf bank_mask:0xf
    v_add_f32_dpp v56, v56, v56 row_ror:8 row_mask:0xf bank_mask:0xf
    v_add_f32_dpp v60, v60, v60 row_ror:8 row_mask:0xf bank_mask:0xf
    v_mul_f32 v32, v32, v24
    v_mul_f32 v36, v36, v24
    v_mul_f32 v40, v40, v25
    v_mul_f32 v44, v44, v25
    v_mul_f32 v48, v48, v26
    v_mul_f32 v52, v52, v26
    v_mul_f32 v56, v56, v27
    v_mul_f32 v60, v60, v27
    s_add_u32 s21, s78, 32
    s_mul_i32 s21, s21, 10240
    s_lshl_b32 s22, s79, 8
    s_add_u32 s21, s21, s22
    s_add_u32 s21, s21, 794624
    v_lshlrev_b32 v5, 2, v11
    s_add_u32 s22, s21, 0
    buffer_store_dword v32, v5, s[52:55], s22 offen offset:0 sc1
    s_add_u32 s22, s21, 0
    buffer_store_dword v36, v5, s[52:55], s22 offen offset:16 sc1
    s_add_u32 s22, s21, 2560
    buffer_store_dword v40, v5, s[52:55], s22 offen offset:0 sc1
    s_add_u32 s22, s21, 2560
    buffer_store_dword v44, v5, s[52:55], s22 offen offset:16 sc1
    s_add_u32 s22, s21, 5120
    buffer_store_dword v48, v5, s[52:55], s22 offen offset:0 sc1
    s_add_u32 s22, s21, 5120
    buffer_store_dword v52, v5, s[52:55], s22 offen offset:16 sc1
    s_add_u32 s22, s21, 7680
    buffer_store_dword v56, v5, s[52:55], s22 offen offset:0 sc1
    s_add_u32 s22, s21, 7680
    buffer_store_dword v60, v5, s[52:55], s22 offen offset:16 sc1
L_end:
    s_endpgm
.section .rodata,"a"
.p2align 6
.amdhsa_kernel pre_kernel
  .amdhsa_next_free_vgpr 104
  .amdhsa_next_free_sgpr 80
  .amdhsa_accum_offset 104
  .amdhsa_group_segment_fixed_size 0
  .amdhsa_kernarg_size 104
  .amdhsa_user_sgpr_count 2
  .amdhsa_user_sgpr_kernarg_segment_ptr 1
  .amdhsa_system_sgpr_workgroup_id_x 1
.end_amdhsa_kernel
.p2align 6
.amdhsa_kernel main_kernel
  .amdhsa_next_free_vgpr 136
  .amdhsa_next_free_sgpr 96
  .amdhsa_accum_offset 136
  .amdhsa_group_segment_fixed_size 0
  .amdhsa_kernarg_size 104
  .amdhsa_user_sgpr_count 2
  .amdhsa_user_sgpr_kernarg_segment_ptr 1
  .amdhsa_system_sgpr_workgroup_id_x 1
.end_amdhsa_kernel
```
